```python
import torch

def _softmax(x, axis=-1):
    return torch.softmax(x, dim=axis)
def _gelu(x):
    return torch.nn.functional.gelu(x, approximate="tanh")
def _silu(x):
    return torch.nn.functional.silu(x)
def _sigmoid(x):
    return torch.sigmoid(x)
def _layernorm(x, axis=-1, eps=1e-5):
    m = x.mean(dim=axis, keepdim=True)
    v = x.var(dim=axis, keepdim=True, unbiased=False)
    return (x - m) / torch.sqrt(v + eps)
def _scatter_add(tgt, idx, src, axis=0):
    return tgt.clone().index_add_(axis, idx, src)
def _segment_sum(src, seg, n):
    out = torch.zeros((n,) + src.shape[1:], dtype=src.dtype)
    return out.index_add_(0, seg, src)
def _pad(x, pw):
    flat = tuple(v for pair in reversed(pw) for v in pair)
    return torch.nn.functional.pad(x, flat)

kernel_name = 'recurrent_scan__softmax_full_mha__dense_activation_squared_relu__prompt'

def setup_inputs():

    _w = (lambda a: (lambda t: t.to(torch.bfloat16) if t.is_floating_point() else t)(torch.as_tensor(a)))
    def _A_setup():
        B, S, D = 1, 2048, 512
        return {
            "x": _w((lambda *s: torch.randn(*s, dtype=torch.bfloat16) * 0.05)(B, S, D)),
            "wqkv": _w((lambda *s: torch.randn(*s, dtype=torch.bfloat16) * 0.05)(D, 3 * D)),
            "wo": _w((lambda *s: torch.randn(*s, dtype=torch.bfloat16) * 0.05)(D, D)),
        }
    _A_in = _A_setup()

    def _B_setup():
        B, S, D, F = 1, 2048, 512, 1792
        return {
            "x": _w((lambda *s: torch.randn(*s, dtype=torch.bfloat16) * 0.05)(B, S, D)),
            "w1": _w((lambda *s: torch.randn(*s, dtype=torch.bfloat16) * 0.05)(D, F)),
            "b1": _w((lambda *s: torch.randn(*s, dtype=torch.bfloat16) * 0.4)(F)),
            "w2": _w((lambda *s: torch.randn(*s, dtype=torch.bfloat16) * 0.05)(F, D)),
            "b2": _w((lambda *s: torch.randn(*s, dtype=torch.bfloat16) * 1.6)(D)),
        }
    _B_in = _B_setup()

    return {
        "A_x": _A_in["x"],
        "A_wqkv": _A_in["wqkv"],
        "A_wo": _A_in["wo"],
        "B_x": _B_in["x"],
        "B_w1": _B_in["w1"],
        "B_b1": _B_in["b1"],
        "B_w2": _B_in["w2"],
        "B_b2": _B_in["b2"],
    }

def reference(A_x, A_wqkv, A_wo, B_x, B_w1, B_b1, B_w2, B_b2):
    def _A_ref(x, wqkv, wo):
        B, S, D = x.shape
        H = 32; Dh = D // H
        qkv = (lambda x, *d: x.permute(*d))((x @ wqkv).reshape(B, S, 3, H, Dh), 2, 0, 3, 1, 4)
        q, k, v = qkv[0], qkv[1], qkv[2]
        scale = Dh ** -0.5
        scores = torch.einsum("bhqd,bhkd->bhqk", q, k) * scale
        p = _softmax(scores, axis=-1)
        o = torch.einsum("bhqk,bhkd->bhqd", p, v)
        return (lambda x, *d: x.permute(*d))(o, 0, 2, 1, 3).reshape(B, S, D) @ wo

    def _B_ref(x, w1, b1, w2, b2):
        h = torch.einsum("bsd,df->bsf", x, w1) + b1
        zero = torch.zeros_like(h)
        r = torch.where(h > zero, h, zero)
        h = r * r
        out = torch.einsum("bsf,fd->bsd", h, w2) + b2
        return out

    x = A_x
    xn = _layernorm(x, axis=-1)
    s = _A_ref(xn, A_wqkv, A_wo)
    g = _silu(_B_ref(xn, B_w1, B_b1, B_w2, B_b2))
    return x + s * g
```

```asm
; @launch kernel=f_kernel grid=(256,1,1) block=(768,1,1) lds=163840
.amdgcn_target "amdgcn-amd-amdhsa--gfx950"
.text
.globl f_kernel
.p2align 12
.type f_kernel,@function
f_kernel:
    s_cmp_ge_u32 s2, 256
    s_cbranch_scc1 F_END
    s_load_dwordx16 s[36:51], s[0:1], 0
    s_load_dwordx2 s[56:57], s[0:1], 80
    s_load_dwordx4 s[52:55], s[0:1], 64
    v_lshrrev_b32 v1, 6, v0
    v_and_b32 v0, 63, v0
    v_readfirstlane_b32 s3, v1
    s_and_b32 s4, s2, 7
    s_lshr_b32 s5, s2, 3
    s_lshr_b32 s32, s5, 1
    s_and_b32 s6, s5, 1
    s_lshl1_add_u32 s33, s4, s6
    s_add_u32 s34, s4, s32
    s_lshl3_add_u32 s4, s6, s4
    s_and_b32 s74, s3, 3
    v_lshlrev_b32 v1, 4, v0
    s_bitcmp1_b32 s3, 2
    s_cbranch_scc1 F_K0
    v_lshrrev_b32 v6, 3, v0
    v_and_b32 v7, 7, v0
    s_cmp_lt_u32 s3, 4
    s_cbranch_scc1 F_G
    v_lshrrev_b32 v8, 4, v0
    v_xor_b32 v8, v8, v7
    v_lshlrev_b32 v140, 10, v6
    v_lshl_add_u32 v140, v8, 4, v140
    v_xor_b32 v141, 64, v140
    v_add_u32 v141, 7168, v141
    v_add_u32 v142, 14336, v140
    v_add_u32 v143, 14336, v141
    s_lshl2_add_u32 s60, s32, s74
    s_lshl_b32 s60, s60, 15
    s_lshl_b32 s61, s74, 12
    s_setprio 2
    s_waitcnt lgkmcnt(0)
    s_mov_b32 s8, s36
    s_mov_b32 s9, s37
    s_mov_b32 s10, 2097152
    s_mov_b32 s11, 0x00020000
    s_add_u32 s66, s34, 0
    s_and_b32 s66, s66, 7
    s_lshl_b32 s67, s66, 7
    s_add_u32 m0, s61, 0
    s_add_u32 s67, s67, s60
    buffer_load_dwordx4 v140, s[8:11], s67 offen offset:0 lds
    buffer_load_dwordx4 v141, s[8:11], s67 offen offset:1024 lds
    buffer_load_dwordx4 v142, s[8:11], s67 offen offset:2048 lds
    buffer_load_dwordx4 v143, s[8:11], s67 offen offset:3072 lds
    s_branch F_A
F_G:
    v_mul_u32_u24 v14, 3072, v6
    v_lshrrev_b32 v6, 2, v0
    v_and_b32 v8, 4, v6
    v_xor_b32 v8, v8, v7
    v_lshl_add_u32 v14, v8, 4, v14
    v_add_u32 v15, 23552, v14
    v_mul_u32_u24 v16, 3072, v6
    v_and_b32 v6, 3, v0
    v_lshl_add_u32 v16, v6, 4, v16
    s_mul_i32 s62, s3, 49152
    s_lshl_b32 s6, s4, 7
    s_add_u32 s61, s62, 1024
    s_add_u32 s61, s61, s6
    s_lshl_b32 s6, s33, 6
    s_add_u32 s62, s62, s6
    s_lshl_b32 s64, s3, 11
    s_lshl_b32 s65, s3, 10
    s_setprio 2
    s_waitcnt lgkmcnt(0)
    s_mov_b32 s12, s38
    s_mov_b32 s13, s39
    s_mov_b32 s14, 1572864
    s_mov_b32 s15, 0x00020000
    s_add_u32 s66, s34, 0
    s_and_b32 s66, s66, 7
    s_mul_i32 s66, s66, 196608
    s_add_u32 m0, s64, 65536
    s_add_u32 s67, s66, s61
    buffer_load_dwordx4 v14, s[12:15], s67 offen offset:0 lds
    buffer_load_dwordx4 v15, s[12:15], s67 offen offset:1024 lds
    s_add_u32 m0, s65, 73728
    s_add_u32 s67, s66, s62
    buffer_load_dwordx4 v16, s[12:15], s67 offen lds
    s_branch F_G2
F_K0:
    s_lshl2_add_u32 s6, s5, s74
    s_bitcmp1_b32 s6, 4
    s_cbranch_scc1 TT0_4
    s_bitcmp1_b32 s6, 3
    s_cbranch_scc1 TT0_3
    s_bitcmp1_b32 s6, 2
    s_cbranch_scc1 TT0_2
    s_bitcmp1_b32 s6, 1
    s_cbranch_scc1 TT0_1
    s_bitcmp1_b32 s6, 0
    s_cbranch_scc1 ST1
    s_branch ST0
TT0_1:
    s_bitcmp1_b32 s6, 0
    s_cbranch_scc1 ST3
    s_branch ST2
TT0_2:
    s_bitcmp1_b32 s6, 1
    s_cbranch_scc1 TT4_1
    s_bitcmp1_b32 s6, 0
    s_cbranch_scc1 ST5
    s_branch ST4
TT4_1:
    s_bitcmp1_b32 s6, 0
    s_cbranch_scc1 ST7
    s_branch ST6
TT0_3:
    s_bitcmp1_b32 s6, 2
    s_cbranch_scc1 TT8_2
    s_bitcmp1_b32 s6, 1
    s_cbranch_scc1 TT8_1
    s_bitcmp1_b32 s6, 0
    s_cbranch_scc1 ST9
    s_branch ST8
TT8_1:
    s_bitcmp1_b32 s6, 0
    s_cbranch_scc1 ST11
    s_branch ST10
TT8_2:
    s_bitcmp1_b32 s6, 1
    s_cbranch_scc1 TT12_1
    s_bitcmp1_b32 s6, 0
    s_cbranch_scc1 ST13
    s_branch ST12
TT12_1:
    s_bitcmp1_b32 s6, 0
    s_cbranch_scc1 ST15
    s_branch ST14
TT0_4:
    s_bitcmp1_b32 s6, 3
    s_cbranch_scc1 TT16_3
    s_bitcmp1_b32 s6, 2
    s_cbranch_scc1 TT16_2
    s_bitcmp1_b32 s6, 1
    s_cbranch_scc1 TT16_1
    s_bitcmp1_b32 s6, 0
    s_cbranch_scc1 ST17
    s_branch ST16
TT16_1:
    s_bitcmp1_b32 s6, 0
    s_cbranch_scc1 ST19
    s_branch ST18
TT16_2:
    s_bitcmp1_b32 s6, 1
    s_cbranch_scc1 TT20_1
    s_bitcmp1_b32 s6, 0
    s_cbranch_scc1 ST21
    s_branch ST20
TT20_1:
    s_bitcmp1_b32 s6, 0
    s_cbranch_scc1 ST23
    s_branch ST22
TT16_3:
    s_bitcmp1_b32 s6, 2
    s_cbranch_scc1 TT24_2
    s_bitcmp1_b32 s6, 1
    s_cbranch_scc1 TT24_1
    s_bitcmp1_b32 s6, 0
    s_cbranch_scc1 ST25
    s_branch ST24
TT24_1:
    s_bitcmp1_b32 s6, 0
    s_cbranch_scc1 ST27
    s_branch ST26
TT24_2:
    s_bitcmp1_b32 s6, 1
    s_cbranch_scc1 TT28_1
    s_bitcmp1_b32 s6, 0
    s_cbranch_scc1 ST29
    s_branch ST28
TT28_1:
    s_bitcmp1_b32 s6, 0
    s_cbranch_scc1 ST0
    s_branch ST30
F_K1:
    v_and_b32 v159, 15, v0
    v_lshlrev_b32 v159, 4, v159
    v_lshrrev_b32 v9, 5, v0
    v_lshl_add_u32 v159, v9, 8, v159
    v_and_b32 v9, 16, v0
    v_lshl_add_u32 v159, v9, 13, v159
    v_add_u32 v159, 1024, v159
    s_lshl4_add_u32 s6, s74, s32
    s_lshl_b32 s76, s6, 11
    s_and_b32 s6, s4, 7
    s_lshl_b32 s6, s6, 19
    s_add_u32 s76, s76, s6
    s_mov_b32 s6, 512
    s_cmp_lt_u32 s4, 8
    s_cselect_b32 s6, 131072, s6
    s_cselect_b64 vcc, -1, 0
    s_add_u32 s77, s76, s6
    s_add_u32 s78, s76, 262144
    s_add_u32 s79, s78, s6
    v_lshrrev_b32 v158, 1, v1
    v_xor_b32 v158, v158, v1
    v_and_b32 v158, 64, v158
    v_mul_u32_u24 v158, 3, v158
    v_xor_b32 v158, v158, v1
    v_cndmask_b32 v158, v159, v158, vcc
    s_lshr_b32 s6, s32, 3
    s_mul_i32 s6, s6, 0
    v_add_u32 v158, s6, v158
    v_and_b32 v160, 7, v0
    v_lshrrev_b32 v9, 3, v0
    v_lshlrev_b32 v160, 7, v160
    v_lshl_add_u32 v160, v9, 17, v160
    s_and_b32 s7, s4, 8
    s_lshl_b32 s7, s7, 7
    s_add_u32 s6, s6, s7
    v_add_u32 v160, s6, v160
    s_waitcnt lgkmcnt(0)
    s_mov_b32 s16, s56
    s_mov_b32 s17, s57
    s_mov_b32 s18, 268435456
    s_mov_b32 s19, 0x00020000
    s_setprio 2
    s_sub_u32 s58, s3, 4
    s_mov_b32 s35, 0xffff0000
    s_lshr_b32 s82, s58, 2
    s_lshl1_add_u32 s84, s33, s82
    s_lshl2_add_u32 s6, s32, s74
    s_lshl_b32 s85, s6, 15
    s_lshl_b32 s7, s84, 10
    s_add_u32 s85, s85, s7
    s_add_u32 s85, s85, 16777216
    v_mov_b32 v165, 1
    v_mov_b32 v164, 155648
    v_and_b32 v162, 15, v0
    v_lshlrev_b32 v162, 4, v162
    v_lshrrev_b32 v9, 5, v0
    v_lshl_add_u32 v162, v9, 8, v162
    s_mov_b32 s24, s54
    s_mov_b32 s25, s55
    s_mov_b32 s26, 256
    s_mov_b32 s27, 0x00020000
    v_lshrrev_b32 v9, 5, v0
    v_bfe_u32 v10, v0, 2, 2
    v_lshl_add_u32 v9, v9, 3, v10
    v_lshlrev_b32 v6, 7, v9
    s_branch SK0
ST0:
    s_branch F_K1
SK0:
    v_bfe_u32 v9, v0, 3, 1
    v_lshl_add_u32 v6, v9, 6, v6
    v_and_b32 v9, 16, v0
    v_lshl_add_u32 v6, v9, 1, v6
    v_and_b32 v9, 3, v0
    v_lshl_add_u32 v6, v9, 3, v6
    v_add_u32 v6, 65536, v6
    v_lshrrev_b32 v9, 5, v0
    v_bfe_u32 v10, v0, 2, 2
    v_lshl_add_u32 v9, v9, 3, v10
    v_lshlrev_b32 v8, 6, v9
    v_and_b32 v9, 16, v0
    v_lshl_add_u32 v8, v9, 1, v8
    v_and_b32 v9, 3, v0
    v_lshl_add_u32 v8, v9, 3, v8
    v_add_u32 v8, 73728, v8
    v_lshrrev_b32 v9, 2, v0
    v_xor_b32 v9, v9, v0
    v_and_b32 v9, 4, v9
    v_and_b32 v10, 3, v0
    v_or_b32 v9, v9, v10
    v_cmp_eq_u32 vcc, 0, v9
    v_mov_b32 v10, 0x3f803f80
    s_nop 0
    v_cndmask_b32 v14, 0, v10, vcc
    v_mov_b32 v15, v14
    v_mov_b32 v16, v14
    v_mov_b32 v17, v14
    v_and_b32 v11, 31, v0
    v_lshl_add_u32 v13, v11, 4, v164
    v_mov_b32 v18, 0
    v_mov_b32 v19, 0
    v_mov_b32 v20, 0
    v_mov_b32 v21, 0
    v_mov_b32 v22, 0
    v_mov_b32 v23, 0
    v_mov_b32 v24, 0
    v_mov_b32 v25, 0
    v_mov_b32 v26, 0
    v_mov_b32 v27, 0
    v_mov_b32 v28, 0
    v_mov_b32 v29, 0
    s_getreg_b32 s6, hwreg(HW_REG_XCC_ID, 0, 4)
    s_mul_i32 s7, s6, s6
    s_lshl_b32 s7, s7, 9
    s_add_u32 s7, s7, s6
    s_lshl_b32 s7, s7, 6
    s_add_u32 s7, s7, 1
    v_mov_b32 v163, s7
    v_mfma_f32_32x32x16_bf16 v[38:53], v[18:21], v[18:21], 0
    s_lshl_b32 s7, s74, 12
    v_and_b32 v9, 31, v0
    v_lshrrev_b32 v10, 5, v0
    v_bfe_u32 v2, v0, 1, 3
    v_xor_b32 v10, v10, v2
    v_lshlrev_b32 v2, 7, v9
    v_lshl_add_u32 v2, v10, 4, v2
    v_add_u32 v2, s7, v2
    v_xor_b32 v3, 32, v2
    v_xor_b32 v4, 64, v2
    v_xor_b32 v5, 96, v2
    v_mfma_f32_32x32x16_bf16 v[54:69], v[18:21], v[18:21], 0
    v_xor_b32 v7, 64, v6
    s_lshl_b32 s6, s74, 9
    s_add_u32 s6, s6, 157696
    v_lshl_add_u32 v9, v11, 4, s6
    s_lshl_b32 s6, s74, 7
    v_lshl_add_u32 v12, v11, 2, v164
    v_add_u32 v12, s6, v12
    v_lshrrev_b32 v10, 5, v0
    v_lshl_add_u32 v10, v10, 4, v164
    v_add_u32 v10, s6, v10
    s_lshl_b32 s6, s74, 11
    s_add_u32 s6, s6, 147456
    v_add_u32 v11, s6, v1
    s_mov_b32 s62, 0xaaaaaaaa
    s_mov_b32 s63, 0xaaaaaaaa
    s_mov_b32 s64, 0xcccccccc
    s_mov_b32 s65, 0xcccccccc
    s_mov_b32 s60, 0xe4040404
    s_mov_b32 s61, 0xed0320
    s_mov_b32 s69, -37
    s_lshr_b32 s71, s33, 1
    s_lshl_b32 s71, s71, 5
    s_cmp_eq_u32 s58, 0
    s_cselect_b32 s70, -21, 64
    s_movk_i32 s67, 0x4000
    v_mfma_f32_32x32x16_bf16 v[70:85], v[18:21], v[18:21], 0
    s_cmp_lt_u32 s4, 8
    s_cbranch_scc0 FA_KVV
    s_branch FA_KVK
ST1:
    s_branch F_K1
FA_KPK:
    s_mov_b64 exec, 1
    ds_add_u32 v164, v165 offset:7680
    s_mov_b32 exec_lo, -1
    buffer_load_dword v161, v160, s[16:19], s76 offen nt
    s_mov_b64 exec, -1
    s_mov_b32 s92, 320000
FA_KSK:
    v_readfirstlane_b32 s93, v166
    s_bitcmp1_b32 s93, s69
    s_cbranch_scc1 FA_KQK
    ds_read_b32 v166, v164 offset:7800
    s_sub_u32 s92, s92, 1
    s_waitcnt lgkmcnt(0)
    s_cbranch_scc0 FA_KSK
    s_branch FA_KQK
FA_KAK:
    s_mov_b64 exec, 1
    buffer_atomic_add v163, off, s[24:27], s71 sc1
    s_mov_b64 exec, -1
    s_branch FA_KQK
FA_KVK:
    s_barrier
    ds_read_b64_tr_b16 v[98:99], v8 offset:0
    ds_read_b64_tr_b16 v[100:101], v8 offset:256
    ds_read_b128 v[86:89], v2
    ds_read_b64_tr_b16 v[90:91], v6 offset:0
    ds_read_b64_tr_b16 v[92:93], v6 offset:512
    ds_read_b64_tr_b16 v[94:95], v7 offset:0
    ds_read_b64_tr_b16 v[96:97], v7 offset:512
    ds_read_b64_tr_b16 v[114:115], v8 offset:1024
    ds_read_b64_tr_b16 v[116:117], v8 offset:1280
    ds_read_b128 v[102:105], v3
    ds_read_b64_tr_b16 v[106:107], v6 offset:2048
    ds_read_b64_tr_b16 v[108:109], v6 offset:2560
    ds_read_b64_tr_b16 v[110:111], v7 offset:2048
    ds_read_b64_tr_b16 v[112:113], v7 offset:2560
    ds_read_b64_tr_b16 v[130:131], v8 offset:2048
    ds_read_b64_tr_b16 v[132:133], v8 offset:2304
    ds_read_b128 v[118:121], v4
    ds_read_b64_tr_b16 v[122:123], v6 offset:4096
    ds_read_b64_tr_b16 v[124:125], v6 offset:4608
    ds_read_b64_tr_b16 v[126:127], v7 offset:4096
    ds_read_b64_tr_b16 v[128:129], v7 offset:4608
FA_KLK:
    s_waitcnt lgkmcnt(14)
    v_mfma_f32_32x32x16_bf16 v[38:53], v[90:93], v[86:89], v[38:53]
    ds_read_b64_tr_b16 v[146:147], v8 offset:3072
    ds_read_b64_tr_b16 v[148:149], v8 offset:3328
    v_mfma_f32_4x4x4_16b_bf16 v[18:21], v[86:87], v[86:87], v[18:21]
    v_mfma_f32_4x4x4_16b_bf16 v[22:25], v[88:89], v[88:89], v[22:25]
    ds_read_b128 v[134:137], v5
    v_mfma_f32_32x32x16_bf16 v[54:69], v[94:97], v[86:89], v[54:69]
    ds_read_b64_tr_b16 v[138:139], v6 offset:6144
    ds_read_b64_tr_b16 v[140:141], v6 offset:6656
    v_mfma_f32_16x16x32_bf16 v[26:29], v[14:17], v[86:89], v[26:29]
    v_mfma_f32_32x32x16_bf16 v[70:85], v[98:101], v[86:89], v[70:85]
    ds_read_b64_tr_b16 v[142:143], v7 offset:6144
    ds_read_b64_tr_b16 v[144:145], v7 offset:6656
    ds_read_b32 v166, v164 offset:7800
    s_sext_i32_i8 s68, s60
    s_lshl_b32 s68, s68, 12
    s_waitcnt lgkmcnt(14)
    v_mfma_f32_32x32x16_bf16 v[38:53], v[106:109], v[102:105], v[38:53]
    v_add_u32 v2, s67, v2
    v_add_u32 v3, s67, v3
    v_add_u32 v4, s67, v4
    v_add_u32 v5, s67, v5
    v_mfma_f32_4x4x4_16b_bf16 v[18:21], v[102:103], v[102:103], v[18:21]
    v_mfma_f32_4x4x4_16b_bf16 v[22:25], v[104:105], v[104:105], v[22:25]
    v_add_u32 v6, s68, v6
    v_add_u32 v7, s68, v7
    v_add_u32 v8, s68, v8
    v_mfma_f32_32x32x16_bf16 v[54:69], v[110:113], v[102:105], v[54:69]
    s_cmp_gt_i32 s69, 0
    s_waitcnt lgkmcnt(0)
    s_cbranch_scc1 FA_KPK
    s_barrier
    s_cmp_eq_u32 s69, s70
    s_cbranch_scc1 FA_KAK
FA_KQK:
    s_add_u32 s69, s69, 8
    ds_read_b64_tr_b16 v[98:99], v8 offset:0
    ds_read_b64_tr_b16 v[100:101], v8 offset:256
    v_mfma_f32_16x16x32_bf16 v[26:29], v[14:17], v[102:105], v[26:29]
    ds_read_b128 v[86:89], v2
    ds_read_b64_tr_b16 v[90:91], v6 offset:0
    v_mfma_f32_32x32x16_bf16 v[70:85], v[114:117], v[102:105], v[70:85]
    ds_read_b64_tr_b16 v[92:93], v6 offset:512
    ds_read_b64_tr_b16 v[94:95], v7 offset:0
    ds_read_b64_tr_b16 v[96:97], v7 offset:512
    s_waitcnt lgkmcnt(14)
    v_mfma_f32_32x32x16_bf16 v[38:53], v[122:125], v[118:121], v[38:53]
    ds_read_b64_tr_b16 v[114:115], v8 offset:1024
    ds_read_b64_tr_b16 v[116:117], v8 offset:1280
    v_mfma_f32_4x4x4_16b_bf16 v[18:21], v[118:119], v[118:119], v[18:21]
    v_mfma_f32_4x4x4_16b_bf16 v[22:25], v[120:121], v[120:121], v[22:25]
    ds_read_b128 v[102:105], v3
    v_mfma_f32_32x32x16_bf16 v[54:69], v[126:129], v[118:121], v[54:69]
    ds_read_b64_tr_b16 v[106:107], v6 offset:2048
    ds_read_b64_tr_b16 v[108:109], v6 offset:2560
    v_mfma_f32_16x16x32_bf16 v[26:29], v[14:17], v[118:121], v[26:29]
    v_mfma_f32_32x32x16_bf16 v[70:85], v[130:133], v[118:121], v[70:85]
    ds_read_b64_tr_b16 v[110:111], v7 offset:2048
    ds_read_b64_tr_b16 v[112:113], v7 offset:2560
    s_waitcnt lgkmcnt(14)
    v_mfma_f32_32x32x16_bf16 v[38:53], v[138:141], v[134:137], v[38:53]
    ds_read_b64_tr_b16 v[130:131], v8 offset:2048
    ds_read_b64_tr_b16 v[132:133], v8 offset:2304
    v_mfma_f32_4x4x4_16b_bf16 v[18:21], v[134:135], v[134:135], v[18:21]
    v_mfma_f32_4x4x4_16b_bf16 v[22:25], v[136:137], v[136:137], v[22:25]
    ds_read_b128 v[118:121], v4
    v_mfma_f32_32x32x16_bf16 v[54:69], v[142:145], v[134:137], v[54:69]
    ds_read_b64_tr_b16 v[122:123], v6 offset:4096
    ds_read_b64_tr_b16 v[124:125], v6 offset:4608
    v_mfma_f32_16x16x32_bf16 v[26:29], v[14:17], v[134:137], v[26:29]
    v_mfma_f32_32x32x16_bf16 v[70:85], v[146:149], v[134:137], v[70:85]
    s_lshr_b64 s[60:61], s[60:61], 8
    ds_read_b64_tr_b16 v[126:127], v7 offset:4096
    ds_read_b64_tr_b16 v[128:129], v7 offset:4608
    s_cbranch_scc1 FA_KLK
    s_waitcnt lgkmcnt(14)
    v_mfma_f32_4x4x4_16b_bf16 v[18:21], v[86:87], v[86:87], v[18:21]
    ds_read_b64_tr_b16 v[146:147], v8 offset:3072
    ds_read_b64_tr_b16 v[148:149], v8 offset:3328
    ds_read_b128 v[134:137], v5
    v_mfma_f32_4x4x4_16b_bf16 v[22:25], v[88:89], v[88:89], v[22:25]
    ds_read_b64_tr_b16 v[138:139], v6 offset:6144
    ds_read_b64_tr_b16 v[140:141], v6 offset:6656
    v_mfma_f32_16x16x32_bf16 v[26:29], v[14:17], v[86:89], v[26:29]
    ds_read_b64_tr_b16 v[142:143], v7 offset:6144
    ds_read_b64_tr_b16 v[144:145], v7 offset:6656
    s_waitcnt lgkmcnt(14)
    v_mfma_f32_4x4x4_16b_bf16 v[18:21], v[102:103], v[102:103], v[18:21]
    v_mfma_f32_4x4x4_16b_bf16 v[22:25], v[104:105], v[104:105], v[22:25]
    v_mfma_f32_16x16x32_bf16 v[26:29], v[14:17], v[102:105], v[26:29]
    s_waitcnt lgkmcnt(7)
    v_mfma_f32_4x4x4_16b_bf16 v[18:21], v[118:119], v[118:119], v[18:21]
    v_mfma_f32_4x4x4_16b_bf16 v[22:25], v[120:121], v[120:121], v[22:25]
    v_mfma_f32_16x16x32_bf16 v[26:29], v[14:17], v[118:121], v[26:29]
    v_mfma_f32_32x32x16_bf16 v[38:53], v[90:93], v[86:89], v[38:53]
    s_setprio 3
    s_mov_b64 exec, 1
    ds_add_u32 v164, v165 offset:7700
    s_mov_b64 exec, -1
    s_waitcnt lgkmcnt(1)
    v_mfma_f32_4x4x4_16b_bf16 v[18:21], v[134:135], v[134:135], v[18:21]
    v_mfma_f32_4x4x4_16b_bf16 v[22:25], v[136:137], v[136:137], v[22:25]
    v_mfma_f32_16x16x32_bf16 v[26:29], v[14:17], v[134:137], v[26:29]
    v_mfma_f32_32x32x16_bf16 v[38:53], v[106:109], v[102:105], v[38:53]
    s_nop 1
    v_cndmask_b32 v18, v18, v19, s[62:63]
    v_cndmask_b32 v20, v20, v21, s[62:63]
    v_cndmask_b32 v22, v22, v23, s[62:63]
    v_cndmask_b32 v24, v24, v25, s[62:63]
    v_cndmask_b32 v18, v18, v20, s[64:65]
    v_cndmask_b32 v22, v22, v24, s[64:65]
    v_mul_f32 v34, 0x3b000000, v26
    v_mfma_f32_32x32x16_bf16 v[38:53], v[122:125], v[118:121], v[38:53]
    v_add_f32 v18, v18, v22
    ds_read_b32 v166, v164 offset:7700
    ds_read_b128 v[150:153], v13 offset:0
    ds_read_b128 v[154:157], v13 offset:512
    v_cvt_pk_bf16_f32 v30, v34, v34
    v_mov_b32 v19, v18
    v_and_b32 v37, s35, v30
    s_branch SK2
ST2:
    s_branch F_K1
SK2:
    v_sub_f32 v37, v34, v37
    v_permlane32_swap_b32 v18, v19
    v_mfma_f32_32x32x16_bf16 v[38:53], v[138:141], v[134:137], v[38:53]
    v_add_f32 v18, v18, v19
    v_mul_f32 v35, 0x3b000000, v18
    v_fma_f32 v35, -v34, v34, v35
    v_max_f32 v35, 0, v35
    v_add_f32 v35, 0x3727c5ac, v35
    v_rsq_f32 v33, v35
    v_mfma_f32_32x32x16_bf16 v[54:69], v[94:97], v[86:89], v[54:69]
    s_waitcnt lgkmcnt(0)
    v_readfirstlane_b32 s93, v166
    s_cmp_ge_u32 s93, 12
    s_cbranch_scc0 FA_CWK
FA_CRK:
    v_add_f32 v150, v150, v151
    v_add_f32 v152, v152, v153
    v_add_f32 v150, v150, v152
    v_mul_f32 v36, v35, v33
    ds_write_b32 v12, v33 offset:6144
    v_cvt_pk_bf16_f32 v31, v37, v36
    v_and_b32 v37, s35, v31
    v_mfma_f32_32x32x16_bf16 v[54:69], v[110:113], v[102:105], v[54:69]
    v_sub_f32 v37, v36, v37
    v_cvt_pk_bf16_f32 v32, v37, 0
    ds_write_b128 v9, v[30:33]
    ds_read_b128 v[122:125], v13 offset:1024
    v_cvt_pk_bf16_f32 v151, -v150, -v150
    v_and_b32 v152, s35, v151
    v_sub_f32 v152, -v150, v152
    v_mfma_f32_32x32x16_bf16 v[54:69], v[126:129], v[118:121], v[54:69]
    v_cvt_pk_bf16_f32 v90, -v150, v152
    v_lshrrev_b32 v91, 16, v151
    v_mov_b32 v92, 0
    v_mov_b32 v93, 0
    v_mov_b32 v34, v33
    v_mov_b32 v33, 0
    s_mov_b32 exec_lo, 0
    v_mov_b32 v30, 0
    v_mov_b32 v31, 0
    v_mov_b32 v32, 0
    s_mov_b32 exec_lo, -1
    s_nop 0
    v_mfma_f32_32x32x16_bf16 v[38:53], v[90:93], v[30:33], v[38:53]
    ds_read_b32 v166, v164 offset:7772
    v_mov_b32 v2, v162
    s_lshl_b32 s63, s84, 17
    s_lshr_b32 s6, s32, 3
    s_mul_i32 s6, s6, 0
    s_add_u32 s63, s63, s6
    s_lshl4_add_u32 s6, s74, s32
    s_lshl_b32 s6, s6, 11
    s_add_u32 s64, s63, s6
    v_xor_b32 v37, s32, v0
    v_and_b32 v37, 31, v37
    v_lshlrev_b32 v37, 2, v37
    s_lshr_b32 s6, s33, 1
    s_lshl2_add_u32 s6, s6, s74
    s_lshl_b32 s6, s6, 7
    s_add_u32 s68, s6, 21037056
    s_and_b32 s6, s4, 8
    s_lshl1_add_u32 s6, s6, s32
    s_lshl2_add_u32 s72, s6, s68
    s_mov_b32 s66, 0xffff
    s_mov_b32 s62, 0
    s_mov_b32 s70, 0x0000ffff
    s_mov_b32 s71, 0x0000ffff
    s_mov_b32 s59, 0
    s_mov_b32 s69, 0
    v_add_f32 v154, v154, v155
    v_add_f32 v156, v156, v157
    v_add_f32 v154, v154, v156
    v_cvt_pk_bf16_f32 v155, -v154, -v154
    v_and_b32 v156, s35, v155
    v_sub_f32 v156, -v154, v156
    v_cvt_pk_bf16_f32 v106, -v154, v156
    v_lshrrev_b32 v107, 16, v155
    v_mov_b32 v108, 0
    v_mov_b32 v109, 0
    v_mfma_f32_32x32x16_bf16 v[54:69], v[142:145], v[134:137], v[54:69]
    s_waitcnt vmcnt(0) lgkmcnt(0)
    v_readfirstlane_b32 s6, v166
    s_cmp_lg_u32 s6, 0
    v_mul_f32 v38, v38, v34
    v_mul_f32 v39, v39, v34
    v_cvt_pk_bf16_f32 v38, v38, v39
    v_mul_f32 v40, v40, v34
    v_mul_f32 v41, v41, v34
    v_cvt_pk_bf16_f32 v39, v40, v41
    v_mfma_f32_32x32x16_bf16 v[54:69], v[106:109], v[30:33], v[54:69]
    v_mul_f32 v42, v42, v34
    v_mul_f32 v43, v43, v34
    v_cvt_pk_bf16_f32 v40, v42, v43
    v_mul_f32 v44, v44, v34
    v_mul_f32 v45, v45, v34
    v_cvt_pk_bf16_f32 v41, v44, v45
    s_cbranch_scc1 S1_1
    buffer_store_dwordx4 v[38:41], v158, s[16:19], s76 offen sc1
    s_branch S2_2
S1_1:
    buffer_store_dwordx4 v[38:41], v158, s[16:19], s76 offen
S2_2:
    v_mul_f32 v46, v46, v34
    v_mul_f32 v47, v47, v34
    v_cvt_pk_bf16_f32 v46, v46, v47
    v_mul_f32 v48, v48, v34
    v_mul_f32 v49, v49, v34
    v_cvt_pk_bf16_f32 v47, v48, v49
    v_mfma_f32_32x32x16_bf16 v[70:85], v[98:101], v[86:89], v[70:85]
    v_mul_f32 v50, v50, v34
    v_mul_f32 v51, v51, v34
    v_cvt_pk_bf16_f32 v48, v50, v51
    v_mul_f32 v52, v52, v34
    v_mul_f32 v53, v53, v34
    v_cvt_pk_bf16_f32 v49, v52, v53
    s_cbranch_scc1 S1_3
    buffer_store_dwordx4 v[46:49], v158, s[16:19], s77 offen sc1
    s_branch S2_4
S1_3:
    buffer_store_dwordx4 v[46:49], v158, s[16:19], s77 offen
S2_4:
    v_mul_f32 v54, v54, v34
    v_mul_f32 v55, v55, v34
    v_cvt_pk_bf16_f32 v54, v54, v55
    v_mul_f32 v56, v56, v34
    v_mul_f32 v57, v57, v34
    v_cvt_pk_bf16_f32 v55, v56, v57
    v_mfma_f32_32x32x16_bf16 v[70:85], v[114:117], v[102:105], v[70:85]
    v_mul_f32 v58, v58, v34
    v_mul_f32 v59, v59, v34
    v_cvt_pk_bf16_f32 v56, v58, v59
    v_mul_f32 v60, v60, v34
    v_mul_f32 v61, v61, v34
    v_cvt_pk_bf16_f32 v57, v60, v61
    s_cbranch_scc1 S1_5
    buffer_store_dwordx4 v[54:57], v158, s[16:19], s78 offen sc1
    s_branch S2_6
S1_5:
    buffer_store_dwordx4 v[54:57], v158, s[16:19], s78 offen
S2_6:
    v_mul_f32 v62, v62, v34
    v_mul_f32 v63, v63, v34
    v_cvt_pk_bf16_f32 v62, v62, v63
    v_mul_f32 v64, v64, v34
    v_mul_f32 v65, v65, v34
    v_cvt_pk_bf16_f32 v63, v64, v65
    v_mfma_f32_32x32x16_bf16 v[70:85], v[130:133], v[118:121], v[70:85]
    v_mul_f32 v66, v66, v34
    v_mul_f32 v67, v67, v34
    v_cvt_pk_bf16_f32 v64, v66, v67
    v_mul_f32 v68, v68, v34
    v_mul_f32 v69, v69, v34
    v_cvt_pk_bf16_f32 v65, v68, v69
    s_cbranch_scc1 S1_7
    buffer_store_dwordx4 v[62:65], v158, s[16:19], s79 offen sc1
    s_branch S2_8
S1_7:
    buffer_store_dwordx4 v[62:65], v158, s[16:19], s79 offen
S2_8:
    ds_read_b64 v[162:163], v164 offset:7768
    v_mfma_f32_32x32x16_bf16 v[70:85], v[146:149], v[134:137], v[70:85]
    v_add_f32 v122, v122, v123
    v_add_f32 v124, v124, v125
    v_add_f32 v122, v122, v124
    v_cvt_pk_bf16_f32 v123, -v122, -v122
    v_and_b32 v124, s35, v123
    v_sub_f32 v124, -v122, v124
    v_cvt_pk_bf16_f32 v138, -v122, v124
    v_lshrrev_b32 v139, 16, v123
    v_mov_b32 v140, 0
    v_mov_b32 v141, 0
    s_nop 1
    v_mfma_f32_32x32x16_bf16 v[70:85], v[138:141], v[30:33], v[70:85]
    s_waitcnt lgkmcnt(0)
    v_readfirstlane_b32 s93, v162
    s_cmp_eq_u32 s93, 0
    s_cbranch_scc1 FA_HWK
FA_HRK:
    v_readfirstlane_b32 s73, v163
    v_mov_b64 v[20:21], 0
    v_mov_b64 v[22:23], 0
    v_mov_b32 v39, 0xdddddddd
    s_nop 0
    v_mfma_f32_32x32x16_bf16 v[88:103], v[20:23], v[20:23], 0
    v_and_b32 v4, 27, v0
    v_cmp_eq_u32 vcc, 16, v4
    v_mov_b32 v4, 0x3f803f80
    v_add_u32 v3, s74, v0
    v_cndmask_b32 v4, 0, v4, vcc
    v_add_u32 v3, 1, v3
    v_mov_b32 v5, v4
    v_mfma_f32_32x32x16_bf16 v[104:119], v[20:23], v[20:23], 0
    v_and_b32 v3, 3, v3
    s_lshl_b32 s6, s82, 2
    v_add_u32 v3, s6, v3
    v_lshl_add_u32 v3, v3, 2, v164
    s_lshl_b32 s6, s58, 2
    v_add_u32 v7, s6, v164
    s_lshl1_add_u32 s6, s74, s82
    v_mfma_f32_32x32x16_bf16 v[120:135], v[20:23], v[20:23], 0
    s_lshl_b32 s6, s6, 10
    s_add_u32 s6, s6, 147456
    v_add_u32 v6, s6, v1
    v_mov_b64 v[12:13], v[4:5]
    v_mov_b64 v[14:15], v[4:5]
    v_mov_b64 v[16:17], v[4:5]
    v_mov_b64 v[18:19], v[4:5]
    v_mfma_f32_32x32x16_bf16 v[136:151], v[20:23], v[20:23], 0
    v_mov_b64 v[24:25], v[4:5]
    v_mov_b64 v[26:27], v[4:5]
    v_mov_b64 v[28:29], v[4:5]
    v_mov_b64 v[30:31], v[4:5]
    v_mov_b64 v[156:157], v[4:5]
    v_mov_b64 v[158:159], v[4:5]
    v_mov_b64 v[160:161], v[4:5]
    v_mov_b64 v[162:163], v[4:5]
    s_branch SK3
ST3:
    s_branch F_K1
SK3:
    s_mov_b64 exec, 1
    s_cmp_lg_u32 s73, 0
    s_waitcnt vmcnt(0)
    s_cbranch_scc1 S1_9
    buffer_store_dword v165, off, s[16:19], s72 sc1
    s_branch S2_10
S1_9:
    buffer_store_dword v165, off, s[16:19], s72
S2_10:
    s_mov_b64 exec, -1
    buffer_load_dword v5, v37, s[16:19], s68 offen nt
    v_mul_f32 v34, 0x3eb8aa3b, v34
    v_mul_f32 v70, v70, v34
    v_mul_f32 v71, v71, v34
    v_cvt_pk_bf16_f32 v70, v70, v71
    v_mul_f32 v72, v72, v34
    v_mul_f32 v73, v73, v34
    v_cvt_pk_bf16_f32 v71, v72, v73
    v_mul_f32 v74, v74, v34
    v_mul_f32 v75, v75, v34
    v_cvt_pk_bf16_f32 v72, v74, v75
    v_mul_f32 v76, v76, v34
    v_mul_f32 v77, v77, v34
    v_cvt_pk_bf16_f32 v73, v76, v77
    ds_write_b128 v11, v[70:73] offset:0
    v_mul_f32 v78, v78, v34
    v_mul_f32 v79, v79, v34
    v_cvt_pk_bf16_f32 v78, v78, v79
    v_mul_f32 v80, v80, v34
    v_mul_f32 v81, v81, v34
    v_cvt_pk_bf16_f32 v79, v80, v81
    v_mul_f32 v82, v82, v34
    v_mul_f32 v83, v83, v34
    v_cvt_pk_bf16_f32 v80, v82, v83
    v_mul_f32 v84, v84, v34
    v_mul_f32 v85, v85, v34
    v_cvt_pk_bf16_f32 v81, v84, v85
    ds_write_b128 v11, v[78:81] offset:1024
    s_mov_b64 exec, 1
    ds_add_u32 v164, v165 offset:7688
    s_mov_b64 exec, -1
    s_branch FA_EJ
.p2align 12
ST4:
    s_branch F_K1
FA_KPV:
    s_mov_b64 exec, 1
    ds_add_u32 v164, v165 offset:7680
    s_mov_b32 exec_lo, -1
    buffer_load_dword v161, v160, s[16:19], s76 offen nt
    s_mov_b64 exec, -1
    s_mov_b32 s92, 320000
FA_KSV:
    v_readfirstlane_b32 s93, v166
    s_bitcmp1_b32 s93, s69
    s_cbranch_scc1 FA_KQV
    ds_read_b32 v166, v164 offset:7800
    s_sub_u32 s92, s92, 1
    s_waitcnt lgkmcnt(0)
    s_cbranch_scc0 FA_KSV
    s_branch FA_KQV
FA_KAV:
    s_mov_b64 exec, 1
    buffer_atomic_add v163, off, s[24:27], s71 sc1
    s_mov_b64 exec, -1
    s_branch FA_KQV
FA_KVV:
    s_barrier
    ds_read_b64_tr_b16 v[98:99], v8 offset:0
    ds_read_b64_tr_b16 v[100:101], v8 offset:256
    ds_read_b128 v[86:89], v2
    ds_read_b64_tr_b16 v[90:91], v6 offset:0
    ds_read_b64_tr_b16 v[92:93], v6 offset:512
    ds_read_b64_tr_b16 v[94:95], v7 offset:0
    ds_read_b64_tr_b16 v[96:97], v7 offset:512
    ds_read_b64_tr_b16 v[114:115], v8 offset:1024
    ds_read_b64_tr_b16 v[116:117], v8 offset:1280
    ds_read_b128 v[102:105], v3
    ds_read_b64_tr_b16 v[106:107], v6 offset:2048
    ds_read_b64_tr_b16 v[108:109], v6 offset:2560
    ds_read_b64_tr_b16 v[110:111], v7 offset:2048
    ds_read_b64_tr_b16 v[112:113], v7 offset:2560
    ds_read_b64_tr_b16 v[130:131], v8 offset:2048
    ds_read_b64_tr_b16 v[132:133], v8 offset:2304
    ds_read_b128 v[118:121], v4
    ds_read_b64_tr_b16 v[122:123], v6 offset:4096
    ds_read_b64_tr_b16 v[124:125], v6 offset:4608
    ds_read_b64_tr_b16 v[126:127], v7 offset:4096
    ds_read_b64_tr_b16 v[128:129], v7 offset:4608
FA_KLV:
    s_waitcnt lgkmcnt(14)
    v_mfma_f32_32x32x16_bf16 v[38:53], v[86:89], v[90:93], v[38:53]
    ds_read_b64_tr_b16 v[146:147], v8 offset:3072
    ds_read_b64_tr_b16 v[148:149], v8 offset:3328
    v_mfma_f32_4x4x4_16b_bf16 v[18:21], v[86:87], v[86:87], v[18:21]
    v_mfma_f32_4x4x4_16b_bf16 v[22:25], v[88:89], v[88:89], v[22:25]
    ds_read_b128 v[134:137], v5
    v_mfma_f32_32x32x16_bf16 v[54:69], v[86:89], v[94:97], v[54:69]
    ds_read_b64_tr_b16 v[138:139], v6 offset:6144
    ds_read_b64_tr_b16 v[140:141], v6 offset:6656
    v_mfma_f32_16x16x32_bf16 v[26:29], v[14:17], v[86:89], v[26:29]
    v_mfma_f32_32x32x16_bf16 v[70:85], v[98:101], v[86:89], v[70:85]
    ds_read_b64_tr_b16 v[142:143], v7 offset:6144
    ds_read_b64_tr_b16 v[144:145], v7 offset:6656
    ds_read_b32 v166, v164 offset:7800
    s_sext_i32_i8 s68, s60
    s_lshl_b32 s68, s68, 12
    s_waitcnt lgkmcnt(14)
    v_mfma_f32_32x32x16_bf16 v[38:53], v[102:105], v[106:109], v[38:53]
    v_add_u32 v2, s67, v2
    v_add_u32 v3, s67, v3
    v_add_u32 v4, s67, v4
    v_add_u32 v5, s67, v5
    v_mfma_f32_4x4x4_16b_bf16 v[18:21], v[102:103], v[102:103], v[18:21]
    v_mfma_f32_4x4x4_16b_bf16 v[22:25], v[104:105], v[104:105], v[22:25]
    v_add_u32 v6, s68, v6
    v_add_u32 v7, s68, v7
    v_add_u32 v8, s68, v8
    v_mfma_f32_32x32x16_bf16 v[54:69], v[102:105], v[110:113], v[54:69]
    s_cmp_gt_i32 s69, 0
    s_waitcnt lgkmcnt(0)
    s_cbranch_scc1 FA_KPV
    s_barrier
    s_cmp_eq_u32 s69, s70
    s_cbranch_scc1 FA_KAV
FA_KQV:
    s_add_u32 s69, s69, 8
    ds_read_b64_tr_b16 v[98:99], v8 offset:0
    ds_read_b64_tr_b16 v[100:101], v8 offset:256
    v_mfma_f32_16x16x32_bf16 v[26:29], v[14:17], v[102:105], v[26:29]
    ds_read_b128 v[86:89], v2
    ds_read_b64_tr_b16 v[90:91], v6 offset:0
    v_mfma_f32_32x32x16_bf16 v[70:85], v[114:117], v[102:105], v[70:85]
    ds_read_b64_tr_b16 v[92:93], v6 offset:512
    ds_read_b64_tr_b16 v[94:95], v7 offset:0
    ds_read_b64_tr_b16 v[96:97], v7 offset:512
    s_waitcnt lgkmcnt(14)
    v_mfma_f32_32x32x16_bf16 v[38:53], v[118:121], v[122:125], v[38:53]
    ds_read_b64_tr_b16 v[114:115], v8 offset:1024
    ds_read_b64_tr_b16 v[116:117], v8 offset:1280
    v_mfma_f32_4x4x4_16b_bf16 v[18:21], v[118:119], v[118:119], v[18:21]
    v_mfma_f32_4x4x4_16b_bf16 v[22:25], v[120:121], v[120:121], v[22:25]
    ds_read_b128 v[102:105], v3
    v_mfma_f32_32x32x16_bf16 v[54:69], v[118:121], v[126:129], v[54:69]
    ds_read_b64_tr_b16 v[106:107], v6 offset:2048
    ds_read_b64_tr_b16 v[108:109], v6 offset:2560
    v_mfma_f32_16x16x32_bf16 v[26:29], v[14:17], v[118:121], v[26:29]
    v_mfma_f32_32x32x16_bf16 v[70:85], v[130:133], v[118:121], v[70:85]
    ds_read_b64_tr_b16 v[110:111], v7 offset:2048
    ds_read_b64_tr_b16 v[112:113], v7 offset:2560
    s_waitcnt lgkmcnt(14)
    v_mfma_f32_32x32x16_bf16 v[38:53], v[134:137], v[138:141], v[38:53]
    ds_read_b64_tr_b16 v[130:131], v8 offset:2048
    ds_read_b64_tr_b16 v[132:133], v8 offset:2304
    v_mfma_f32_4x4x4_16b_bf16 v[18:21], v[134:135], v[134:135], v[18:21]
    v_mfma_f32_4x4x4_16b_bf16 v[22:25], v[136:137], v[136:137], v[22:25]
    ds_read_b128 v[118:121], v4
    v_mfma_f32_32x32x16_bf16 v[54:69], v[134:137], v[142:145], v[54:69]
    ds_read_b64_tr_b16 v[122:123], v6 offset:4096
    ds_read_b64_tr_b16 v[124:125], v6 offset:4608
    v_mfma_f32_16x16x32_bf16 v[26:29], v[14:17], v[134:137], v[26:29]
    v_mfma_f32_32x32x16_bf16 v[70:85], v[146:149], v[134:137], v[70:85]
    s_lshr_b64 s[60:61], s[60:61], 8
    ds_read_b64_tr_b16 v[126:127], v7 offset:4096
    ds_read_b64_tr_b16 v[128:129], v7 offset:4608
    s_cbranch_scc1 FA_KLV
    s_waitcnt lgkmcnt(14)
    v_mfma_f32_4x4x4_16b_bf16 v[18:21], v[86:87], v[86:87], v[18:21]
    ds_read_b64_tr_b16 v[146:147], v8 offset:3072
    ds_read_b64_tr_b16 v[148:149], v8 offset:3328
    ds_read_b128 v[134:137], v5
    v_mfma_f32_4x4x4_16b_bf16 v[22:25], v[88:89], v[88:89], v[22:25]
    ds_read_b64_tr_b16 v[138:139], v6 offset:6144
    ds_read_b64_tr_b16 v[140:141], v6 offset:6656
    v_mfma_f32_16x16x32_bf16 v[26:29], v[14:17], v[86:89], v[26:29]
    ds_read_b64_tr_b16 v[142:143], v7 offset:6144
    ds_read_b64_tr_b16 v[144:145], v7 offset:6656
    s_waitcnt lgkmcnt(14)
    v_mfma_f32_4x4x4_16b_bf16 v[18:21], v[102:103], v[102:103], v[18:21]
    v_mfma_f32_4x4x4_16b_bf16 v[22:25], v[104:105], v[104:105], v[22:25]
    v_mfma_f32_16x16x32_bf16 v[26:29], v[14:17], v[102:105], v[26:29]
    s_waitcnt lgkmcnt(7)
    v_mfma_f32_4x4x4_16b_bf16 v[18:21], v[118:119], v[118:119], v[18:21]
    v_mfma_f32_4x4x4_16b_bf16 v[22:25], v[120:121], v[120:121], v[22:25]
    v_mfma_f32_16x16x32_bf16 v[26:29], v[14:17], v[118:121], v[26:29]
    v_mfma_f32_32x32x16_bf16 v[38:53], v[86:89], v[90:93], v[38:53]
    s_setprio 3
    s_mov_b64 exec, 1
    ds_add_u32 v164, v165 offset:7700
    s_mov_b64 exec, -1
    s_waitcnt lgkmcnt(1)
    v_mfma_f32_4x4x4_16b_bf16 v[18:21], v[134:135], v[134:135], v[18:21]
    v_mfma_f32_4x4x4_16b_bf16 v[22:25], v[136:137], v[136:137], v[22:25]
    v_mfma_f32_16x16x32_bf16 v[26:29], v[14:17], v[134:137], v[26:29]
    v_mfma_f32_32x32x16_bf16 v[38:53], v[102:105], v[106:109], v[38:53]
    s_nop 1
    v_cndmask_b32 v18, v18, v19, s[62:63]
    v_cndmask_b32 v20, v20, v21, s[62:63]
    v_cndmask_b32 v22, v22, v23, s[62:63]
    v_cndmask_b32 v24, v24, v25, s[62:63]
    v_cndmask_b32 v18, v18, v20, s[64:65]
    v_cndmask_b32 v22, v22, v24, s[64:65]
    v_mul_f32 v34, 0x3b000000, v26
    v_add_f32 v18, v18, v22
    v_mfma_f32_32x32x16_bf16 v[38:53], v[118:121], v[122:125], v[38:53]
    ds_read_b32 v166, v164 offset:7700
    ds_read_b128 v[150:153], v13 offset:0
    ds_read_b128 v[154:157], v13 offset:512
    v_cvt_pk_bf16_f32 v30, v34, v34
    v_mov_b32 v19, v18
    v_and_b32 v37, s35, v30
    s_branch SK5
ST5:
    s_branch F_K1
SK5:
    v_sub_f32 v37, v34, v37
    v_permlane32_swap_b32 v18, v19
    v_add_f32 v18, v18, v19
    v_mfma_f32_32x32x16_bf16 v[38:53], v[134:137], v[138:141], v[38:53]
    v_mul_f32 v35, 0x3b000000, v18
    v_fma_f32 v35, -v34, v34, v35
    v_max_f32 v35, 0, v35
    v_add_f32 v35, 0x3727c5ac, v35
    v_rsq_f32 v33, v35
    s_waitcnt lgkmcnt(0)
    v_readfirstlane_b32 s93, v166
    s_cmp_ge_u32 s93, 12
    s_cbranch_scc0 FA_CWV
FA_CRV:
    v_add_f32 v150, v150, v151
    v_add_f32 v152, v152, v153
    v_mfma_f32_32x32x16_bf16 v[54:69], v[86:89], v[94:97], v[54:69]
    v_add_f32 v150, v150, v152
    v_mul_f32 v36, v35, v33
    ds_write_b32 v12, v33 offset:6144
    ds_read_b128 v[14:17], v10 offset:6144
    ds_read_b128 v[18:21], v10 offset:6176
    ds_read_b128 v[22:25], v10 offset:6208
    ds_read_b128 v[26:29], v10 offset:6240
    v_cvt_pk_bf16_f32 v31, v37, v36
    v_mfma_f32_32x32x16_bf16 v[54:69], v[102:105], v[110:113], v[54:69]
    v_and_b32 v37, s35, v31
    v_sub_f32 v37, v36, v37
    v_cvt_pk_bf16_f32 v32, v37, 0
    ds_write_b128 v9, v[30:33]
    ds_read_b128 v[122:125], v13 offset:1024
    v_cvt_pk_bf16_f32 v151, -v150, -v150
    v_and_b32 v152, s35, v151
    v_mfma_f32_32x32x16_bf16 v[54:69], v[118:121], v[126:129], v[54:69]
    v_sub_f32 v152, -v150, v152
    v_cvt_pk_bf16_f32 v90, -v150, v152
    v_lshrrev_b32 v91, 16, v151
    v_mov_b32 v92, 0
    v_mov_b32 v93, 0
    v_mov_b32 v34, v33
    v_mov_b32 v33, 0
    s_mov_b32 exec_lo, 0
    v_mov_b32 v30, 0
    v_mov_b32 v31, 0
    v_mov_b32 v32, 0
    s_mov_b32 exec_lo, -1
    s_nop 0
    v_mfma_f32_32x32x16_bf16 v[38:53], v[30:33], v[90:93], v[38:53]
    ds_read_b32 v166, v164 offset:7772
    v_mov_b32 v2, v162
    s_lshl_b32 s63, s84, 17
    s_lshr_b32 s6, s32, 3
    s_mul_i32 s6, s6, 0
    s_add_u32 s63, s63, s6
    s_lshl4_add_u32 s6, s74, s32
    s_lshl_b32 s6, s6, 11
    s_add_u32 s64, s63, s6
    v_xor_b32 v37, s32, v0
    v_and_b32 v37, 31, v37
    v_lshlrev_b32 v37, 2, v37
    s_lshr_b32 s6, s33, 1
    s_lshl2_add_u32 s6, s6, s74
    s_lshl_b32 s6, s6, 7
    s_add_u32 s68, s6, 21037056
    s_and_b32 s6, s4, 8
    s_lshl1_add_u32 s6, s6, s32
    s_lshl2_add_u32 s72, s6, s68
    s_mov_b32 s66, 0xffff
    s_mov_b32 s62, 0
    s_mov_b32 s70, 0x0000ffff
    s_mov_b32 s71, 0x0000ffff
    s_mov_b32 s59, 0
    s_mov_b32 s69, 0
    v_add_f32 v154, v154, v155
    v_add_f32 v156, v156, v157
    v_add_f32 v154, v154, v156
    v_cvt_pk_bf16_f32 v155, -v154, -v154
    v_and_b32 v156, s35, v155
    v_sub_f32 v156, -v154, v156
    v_cvt_pk_bf16_f32 v106, -v154, v156
    v_lshrrev_b32 v107, 16, v155
    v_mov_b32 v108, 0
    v_mov_b32 v109, 0
    v_mfma_f32_32x32x16_bf16 v[54:69], v[134:137], v[142:145], v[54:69]
    s_waitcnt vmcnt(0) lgkmcnt(0)
    v_readfirstlane_b32 s6, v166
    s_cmp_lg_u32 s6, 0
    v_mul_f32 v38, v38, v14
    v_mul_f32 v39, v39, v15
    v_cvt_pk_bf16_f32 v38, v38, v39
    v_mul_f32 v40, v40, v16
    v_mul_f32 v41, v41, v17
    v_cvt_pk_bf16_f32 v39, v40, v41
    v_mfma_f32_32x32x16_bf16 v[54:69], v[30:33], v[106:109], v[54:69]
    v_mul_f32 v42, v42, v18
    v_mul_f32 v43, v43, v19
    v_cvt_pk_bf16_f32 v40, v42, v43
    v_mul_f32 v44, v44, v20
    v_mul_f32 v45, v45, v21
    v_cvt_pk_bf16_f32 v41, v44, v45
    s_cbranch_scc1 S1_11
    buffer_store_dwordx4 v[38:41], v158, s[16:19], s76 offen sc1
    s_branch S2_12
S1_11:
    buffer_store_dwordx4 v[38:41], v158, s[16:19], s76 offen
S2_12:
    v_mul_f32 v46, v46, v22
    v_mul_f32 v47, v47, v23
    v_cvt_pk_bf16_f32 v46, v46, v47
    v_mul_f32 v48, v48, v24
    v_mul_f32 v49, v49, v25
    v_cvt_pk_bf16_f32 v47, v48, v49
    v_mfma_f32_32x32x16_bf16 v[70:85], v[98:101], v[86:89], v[70:85]
    v_mul_f32 v50, v50, v26
    v_mul_f32 v51, v51, v27
    v_cvt_pk_bf16_f32 v48, v50, v51
    v_mul_f32 v52, v52, v28
    v_mul_f32 v53, v53, v29
    v_cvt_pk_bf16_f32 v49, v52, v53
    s_cbranch_scc1 S1_13
    buffer_store_dwordx4 v[46:49], v158, s[16:19], s77 offen sc1
    s_branch S2_14
S1_13:
    buffer_store_dwordx4 v[46:49], v158, s[16:19], s77 offen
S2_14:
    v_mul_f32 v54, v54, v14
    v_mul_f32 v55, v55, v15
    v_cvt_pk_bf16_f32 v54, v54, v55
    v_mul_f32 v56, v56, v16
    v_mul_f32 v57, v57, v17
    v_cvt_pk_bf16_f32 v55, v56, v57
    v_mfma_f32_32x32x16_bf16 v[70:85], v[114:117], v[102:105], v[70:85]
    v_mul_f32 v58, v58, v18
    v_mul_f32 v59, v59, v19
    v_cvt_pk_bf16_f32 v56, v58, v59
    v_mul_f32 v60, v60, v20
    v_mul_f32 v61, v61, v21
    v_cvt_pk_bf16_f32 v57, v60, v61
    s_cbranch_scc1 S1_15
    buffer_store_dwordx4 v[54:57], v158, s[16:19], s78 offen sc1
    s_branch S2_16
S1_15:
    buffer_store_dwordx4 v[54:57], v158, s[16:19], s78 offen
S2_16:
    v_mul_f32 v62, v62, v22
    v_mul_f32 v63, v63, v23
    v_cvt_pk_bf16_f32 v62, v62, v63
    v_mul_f32 v64, v64, v24
    v_mul_f32 v65, v65, v25
    v_cvt_pk_bf16_f32 v63, v64, v65
    v_mfma_f32_32x32x16_bf16 v[70:85], v[130:133], v[118:121], v[70:85]
    v_mul_f32 v66, v66, v26
    v_mul_f32 v67, v67, v27
    v_cvt_pk_bf16_f32 v64, v66, v67
    v_mul_f32 v68, v68, v28
    v_mul_f32 v69, v69, v29
    v_cvt_pk_bf16_f32 v65, v68, v69
    s_cbranch_scc1 S1_17
    buffer_store_dwordx4 v[62:65], v158, s[16:19], s79 offen sc1
    s_branch S2_18
S1_17:
    buffer_store_dwordx4 v[62:65], v158, s[16:19], s79 offen
S2_18:
    ds_read_b64 v[162:163], v164 offset:7768
    v_mfma_f32_32x32x16_bf16 v[70:85], v[146:149], v[134:137], v[70:85]
    v_add_f32 v122, v122, v123
    v_add_f32 v124, v124, v125
    v_add_f32 v122, v122, v124
    v_cvt_pk_bf16_f32 v123, -v122, -v122
    v_and_b32 v124, s35, v123
    v_sub_f32 v124, -v122, v124
    v_cvt_pk_bf16_f32 v138, -v122, v124
    v_lshrrev_b32 v139, 16, v123
    v_mov_b32 v140, 0
    v_mov_b32 v141, 0
    s_nop 1
    v_mfma_f32_32x32x16_bf16 v[70:85], v[138:141], v[30:33], v[70:85]
    s_waitcnt lgkmcnt(0)
    v_readfirstlane_b32 s93, v162
    s_cmp_eq_u32 s93, 0
    s_cbranch_scc1 FA_HWV
FA_HRV:
    v_readfirstlane_b32 s73, v163
    v_mov_b64 v[20:21], 0
    v_mov_b64 v[22:23], 0
    v_mov_b32 v39, 0xdddddddd
    s_nop 0
    v_mfma_f32_32x32x16_bf16 v[88:103], v[20:23], v[20:23], 0
    v_and_b32 v4, 27, v0
    v_cmp_eq_u32 vcc, 16, v4
    v_mov_b32 v4, 0x3f803f80
    v_add_u32 v3, s74, v0
    v_cndmask_b32 v4, 0, v4, vcc
    v_add_u32 v3, 1, v3
    v_mov_b32 v5, v4
    v_mfma_f32_32x32x16_bf16 v[104:119], v[20:23], v[20:23], 0
    v_and_b32 v3, 3, v3
    s_lshl_b32 s6, s82, 2
    v_add_u32 v3, s6, v3
    v_lshl_add_u32 v3, v3, 2, v164
    s_lshl_b32 s6, s58, 2
    v_add_u32 v7, s6, v164
    s_lshl1_add_u32 s6, s74, s82
    v_mfma_f32_32x32x16_bf16 v[120:135], v[20:23], v[20:23], 0
    s_lshl_b32 s6, s6, 10
    s_add_u32 s6, s6, 147456
    v_add_u32 v6, s6, v1
    v_mov_b64 v[12:13], v[4:5]
    v_mov_b64 v[14:15], v[4:5]
    v_mov_b64 v[16:17], v[4:5]
    v_mov_b64 v[18:19], v[4:5]
    v_mfma_f32_32x32x16_bf16 v[136:151], v[20:23], v[20:23], 0
    s_branch SK6
ST6:
    s_branch F_K1
SK6:
    v_mov_b64 v[24:25], v[4:5]
    v_mov_b64 v[26:27], v[4:5]
    v_mov_b64 v[28:29], v[4:5]
    v_mov_b64 v[30:31], v[4:5]
    v_mov_b64 v[156:157], v[4:5]
    v_mov_b64 v[158:159], v[4:5]
    v_mov_b64 v[160:161], v[4:5]
    v_mov_b64 v[162:163], v[4:5]
    s_mov_b64 exec, 1
    s_cmp_lg_u32 s73, 0
    s_waitcnt vmcnt(0)
    s_cbranch_scc1 S1_19
    buffer_store_dword v165, off, s[16:19], s72 sc1
    s_branch S2_20
S1_19:
    buffer_store_dword v165, off, s[16:19], s72
S2_20:
    s_mov_b64 exec, -1
    buffer_load_dword v5, v37, s[16:19], s68 offen nt
    v_mul_f32 v34, 0x3eb8aa3b, v34
    v_mul_f32 v70, v70, v34
    v_mul_f32 v71, v71, v34
    v_cvt_pk_bf16_f32 v70, v70, v71
    v_mul_f32 v72, v72, v34
    v_mul_f32 v73, v73, v34
    v_cvt_pk_bf16_f32 v71, v72, v73
    v_mul_f32 v74, v74, v34
    v_mul_f32 v75, v75, v34
    v_cvt_pk_bf16_f32 v72, v74, v75
    v_mul_f32 v76, v76, v34
    v_mul_f32 v77, v77, v34
    v_cvt_pk_bf16_f32 v73, v76, v77
    ds_write_b128 v11, v[70:73] offset:0
    v_mul_f32 v78, v78, v34
    v_mul_f32 v79, v79, v34
    v_cvt_pk_bf16_f32 v78, v78, v79
    v_mul_f32 v80, v80, v34
    v_mul_f32 v81, v81, v34
    v_cvt_pk_bf16_f32 v79, v80, v81
    v_mul_f32 v82, v82, v34
    v_mul_f32 v83, v83, v34
    v_cvt_pk_bf16_f32 v80, v82, v83
    v_mul_f32 v84, v84, v34
    v_mul_f32 v85, v85, v34
    v_cvt_pk_bf16_f32 v81, v84, v85
    ds_write_b128 v11, v[78:81] offset:1024
    s_mov_b64 exec, 1
    ds_add_u32 v164, v165 offset:7688
    s_mov_b64 exec, -1
FA_EJ:
    s_setprio 3
    s_waitcnt vmcnt(0)
    ds_read_b32 v32, v164 offset:7688
    v_cmp_ne_u32 vcc, 0, v5
    s_lshr_b32 s6, vcc_lo, 16
    s_and_b32 s6, s6, vcc_lo
    s_and_b32 s6, s6, s66
    s_or_b32 s62, s62, s6
    s_xor_b32 s66, s66, s6
    s_cselect_b32 s6, 0, 0xffff0000
    s_or_b32 s62, s62, s6
    s_cmp_eq_u32 s62, 0
    s_cbranch_scc1 FA_SLI
FA_SRI:
    s_ff1_i32_b32 s6, s62
    s_bitset0_b32 s62, s6
    s_lshl_b32 s6, s6, 11
    s_bitset0_b32 s6, 15
    s_xor_b32 s67, s64, s6
    buffer_load_dwordx4 v[8:11], v1, s[16:19], s67 offen nt
    s_mov_b64 exec, s[70:71]
    buffer_load_dwordx4 v[12:15], v2, s[16:19], s67 offen offset:1024 nt
    buffer_load_dwordx4 v[16:19], v2, s[16:19], s67 offen offset:1536 nt
    s_mov_b64 exec, -1
    buffer_load_dword v5, v37, s[16:19], s68 offen nt
    s_waitcnt lgkmcnt(0)
    v_readfirstlane_b32 s93, v32
    s_cmp_ge_u32 s93, 4
    s_cbranch_scc0 FA_QW
FA_QR:
    ds_read_b128 v[72:75], v6
    v_xor_b32 v4, 2048, v6
    ds_read_b128 v[76:79], v4
    v_xor_b32 v4, 4096, v6
    ds_read_b128 v[80:83], v4
    v_xor_b32 v4, 6144, v6
    ds_read_b128 v[84:87], v4
    s_cmp_lt_u32 s58, 4
    s_setprio 3
    s_cbranch_scc1 FA_PP
    s_setprio 2
FA_PP:
    s_waitcnt vmcnt(3) lgkmcnt(3)
    v_mfma_f32_32x32x16_bf16 v[40:55], v[8:11], v[72:75], 0
    s_waitcnt lgkmcnt(0)
    s_mov_b64 exec, 1
    ds_add_u32 v164, v165 offset:7692
    s_mov_b64 exec, -1
    s_waitcnt vmcnt(0)
    v_cmp_ne_u32 vcc, 0, v5
    s_lshr_b32 s6, vcc_lo, 16
    s_and_b32 s6, s6, vcc_lo
    s_and_b32 s6, s6, s66
    s_or_b32 s62, s62, s6
    s_xor_b32 s66, s66, s6
    s_cselect_b32 s6, 0, 0xffff0000
    s_or_b32 s62, s62, s6
    s_cmp_eq_u32 s62, 0
    s_cbranch_scc1 FA_SLJ
FA_SRJ:
    s_ff1_i32_b32 s6, s62
    s_bitset0_b32 s62, s6
    s_lshl_b32 s6, s6, 11
    s_bitset0_b32 s6, 15
    s_xor_b32 s67, s64, s6
    buffer_load_dwordx4 v[20:23], v1, s[16:19], s67 offen nt
    s_mov_b64 exec, s[70:71]
    buffer_load_dwordx4 v[24:27], v2, s[16:19], s67 offen offset:1024 nt
    buffer_load_dwordx4 v[28:31], v2, s[16:19], s67 offen offset:1536 nt
    s_mov_b64 exec, -1
    s_mov_b32 s65, 0x07060302
    v_exp_f32 v40, v40
    v_exp_f32 v41, v41
    v_exp_f32 v42, v42
    v_exp_f32 v43, v43
    v_exp_f32 v44, v44
    v_mfma_f32_32x32x16_bf16 v[56:71], v[8:11], v[76:79], 0
    s_cmp_eq_u32 s62, 0
    s_cbranch_scc1 FA_SLK
FA_SRK:
    s_ff1_i32_b32 s6, s62
    s_bitset0_b32 s62, s6
    s_lshl_b32 s6, s6, 11
    s_bitset0_b32 s6, 15
    s_xor_b32 s67, s64, s6
    buffer_load_dwordx4 v[152:155], v1, s[16:19], s67 offen nt
    s_mov_b64 exec, s[70:71]
    buffer_load_dwordx4 v[156:159], v2, s[16:19], s67 offen offset:1024 nt
    buffer_load_dwordx4 v[160:163], v2, s[16:19], s67 offen offset:1536 nt
    s_mov_b64 exec, -1
    buffer_load_dword v5, v37, s[16:19], s68 offen nt
    v_exp_f32 v45, v45
    v_exp_f32 v46, v46
    v_exp_f32 v47, v47
    v_exp_f32 v48, v48
    v_exp_f32 v49, v49
    v_smfmac_f32_32x32x32_bf16 v[88:103], v[12:15], v[40:47], v39
    v_exp_f32 v50, v50
    v_exp_f32 v51, v51
    v_exp_f32 v52, v52
    v_exp_f32 v53, v53
    v_exp_f32 v54, v54
    v_exp_f32 v55, v55
    v_exp_f32 v56, v56
    v_exp_f32 v57, v57
    v_smfmac_f32_32x32x32_bf16 v[88:103], v[16:19], v[48:55], v39
    v_exp_f32 v58, v58
    v_exp_f32 v59, v59
    v_exp_f32 v60, v60
    v_mfma_f32_32x32x16_bf16 v[40:55], v[8:11], v[80:83], 0
    v_exp_f32 v61, v61
    v_exp_f32 v62, v62
    v_exp_f32 v63, v63
    v_exp_f32 v64, v64
    v_exp_f32 v65, v65
    v_smfmac_f32_32x32x32_bf16 v[104:119], v[12:15], v[56:63], v39
    v_exp_f32 v66, v66
    v_exp_f32 v67, v67
    s_cmp_eq_u32 s62, 0
    s_cbranch_scc1 FA_SL1
FA_SR1:
    s_ff1_i32_b32 s6, s62
    s_bitset0_b32 s62, s6
    s_lshl_b32 s6, s6, 11
    s_bitset0_b32 s6, 15
    s_xor_b32 s67, s64, s6
    s_mov_b32 s12, s48
    s_mov_b32 s13, s49
    s_mov_b32 s14, 1835008
    s_mov_b32 s15, 0x00020000
    s_lshr_b32 s6, s2, 3
    s_lshl3_add_u32 s60, s6, s58
    s_mul_i32 s61, s60, 7168
    s_buffer_load_dwordx2 s[100:101], s[12:15], s61 offset:444
    s_buffer_load_dwordx2 s[100:101], s[12:15], s61 offset:1468
    s_buffer_load_dwordx2 s[100:101], s[12:15], s61 offset:2492
    v_exp_f32 v68, v68
    v_exp_f32 v69, v69
    v_exp_f32 v70, v70
    v_exp_f32 v71, v71
    v_exp_f32 v40, v40
    v_exp_f32 v41, v41
    v_smfmac_f32_32x32x32_bf16 v[104:119], v[16:19], v[64:71], v39
    v_exp_f32 v42, v42
    v_exp_f32 v43, v43
    v_exp_f32 v44, v44
    v_mfma_f32_32x32x16_bf16 v[56:71], v[8:11], v[84:87], 0
    buffer_load_dwordx4 v[8:11], v1, s[16:19], s67 offen nt
    v_exp_f32 v45, v45
    v_exp_f32 v46, v46
    v_exp_f32 v47, v47
    v_exp_f32 v48, v48
    v_exp_f32 v49, v49
    v_smfmac_f32_32x32x32_bf16 v[120:135], v[12:15], v[40:47], v39
    v_exp_f32 v50, v50
    v_exp_f32 v51, v51
    s_buffer_load_dwordx2 s[100:101], s[12:15], s61 offset:3516
    s_buffer_load_dwordx2 s[100:101], s[12:15], s61 offset:4540
    s_buffer_load_dwordx2 s[100:101], s[12:15], s61 offset:5564
    v_exp_f32 v52, v52
    v_exp_f32 v53, v53
    v_exp_f32 v54, v54
    v_exp_f32 v55, v55
    v_exp_f32 v56, v56
    v_exp_f32 v57, v57
    v_smfmac_f32_32x32x32_bf16 v[120:135], v[16:19], v[48:55], v39
    v_exp_f32 v58, v58
    v_exp_f32 v59, v59
    v_exp_f32 v60, v60
    s_waitcnt vmcnt(5)
    v_mfma_f32_32x32x16_bf16 v[40:55], v[20:23], v[72:75], 0
    v_exp_f32 v61, v61
    v_exp_f32 v62, v62
    s_branch SK7
ST7:
    s_branch F_K1
SK7:
    v_exp_f32 v63, v63
    v_exp_f32 v64, v64
    v_exp_f32 v65, v65
    v_smfmac_f32_32x32x32_bf16 v[136:151], v[12:15], v[56:63], v39
    v_exp_f32 v66, v66
    v_exp_f32 v67, v67
    s_buffer_load_dwordx2 s[100:101], s[12:15], s61 offset:6588
    s_waitcnt vmcnt(1)
    v_cmp_ne_u32 vcc, 0, v5
    s_lshr_b32 s6, vcc_lo, 16
    s_and_b32 s6, s6, vcc_lo
    s_and_b32 s6, s6, s66
    s_or_b32 s62, s62, s6
    s_xor_b32 s66, s66, s6
    s_cselect_b32 s6, 0, 0xffff0000
    s_or_b32 s62, s62, s6
    v_exp_f32 v68, v68
    v_exp_f32 v69, v69
    v_exp_f32 v70, v70
    v_exp_f32 v71, v71
    s_branch FA_LOOP
FA_CWK:
    s_mov_b32 s92, 320000
FA_CSK:
    ds_read_b32 v166, v164 offset:7700
    ds_read_b128 v[150:153], v13 offset:0
    ds_read_b128 v[154:157], v13 offset:512
    s_waitcnt lgkmcnt(0)
    v_readfirstlane_b32 s93, v166
    s_cmp_ge_u32 s93, 12
    s_cbranch_scc1 FA_CRK
    s_sub_u32 s92, s92, 1
    s_cbranch_scc0 FA_CSK
    s_branch FA_CRK
FA_HWK:
    s_mov_b32 s92, 320000
LL_7001:
    ds_read_b64 v[162:163], v164 offset:7768
    s_waitcnt lgkmcnt(0)
    v_readfirstlane_b32 s93, v162
    s_cmp_ge_u32 s93, 1
    s_cbranch_scc1 LD_7002
    s_sleep 1
    s_sub_u32 s92, s92, 1
    s_cmp_lg_u32 s92, 0
    s_cbranch_scc1 LL_7001
LD_7002:
    s_branch FA_HRK
FA_CWV:
    s_mov_b32 s92, 320000
FA_CSV:
    ds_read_b32 v166, v164 offset:7700
    ds_read_b128 v[150:153], v13 offset:0
    ds_read_b128 v[154:157], v13 offset:512
    s_waitcnt lgkmcnt(0)
    v_readfirstlane_b32 s93, v166
    s_cmp_ge_u32 s93, 12
    s_cbranch_scc1 FA_CRV
    s_sub_u32 s92, s92, 1
    s_cbranch_scc0 FA_CSV
    s_branch FA_CRV
FA_HWV:
    s_mov_b32 s92, 320000
LL_7101:
    ds_read_b64 v[162:163], v164 offset:7768
    s_waitcnt lgkmcnt(0)
    v_readfirstlane_b32 s93, v162
    s_cmp_ge_u32 s93, 1
    s_cbranch_scc1 LD_7102
    s_sleep 1
    s_sub_u32 s92, s92, 1
    s_cmp_lg_u32 s92, 0
    s_cbranch_scc1 LL_7101
LD_7102:
    s_branch FA_HRV
FA_SLI:
    s_mov_b32 s92, 40000
FA_SMI:
    buffer_load_dword v4, v37, s[16:19], s68 offen sc1
    s_sub_u32 s92, s92, 1
    s_cselect_b32 s7, -1, 0
    s_waitcnt vmcnt(0)
    v_cmp_ne_u32 vcc, 0, v4
    s_lshr_b32 s6, vcc_lo, 16
    s_and_b32 s6, s6, vcc_lo
    s_or_b32 s6, s6, s7
    s_and_b32 s62, s6, s66
    s_cbranch_scc0 FA_SMI
    s_xor_b32 s66, s66, s62
    s_cselect_b32 s6, 0, 0xffff0000
    s_or_b32 s62, s62, s6
    s_branch FA_SRI
FA_QW:
    s_mov_b32 s92, 320000
LL_7301:
    ds_read_b32 v4, v164 offset:7688
    s_waitcnt lgkmcnt(0)
    v_readfirstlane_b32 s93, v4
    s_cmp_ge_u32 s93, 4
    s_cbranch_scc1 LD_7302
    s_sleep 1
    s_sub_u32 s92, s92, 1
    s_cmp_lg_u32 s92, 0
    s_cbranch_scc1 LL_7301
LD_7302:
    s_branch FA_QR
FA_SLJ:
    s_mov_b32 s92, 40000
FA_SMJ:
    buffer_load_dword v4, v37, s[16:19], s68 offen sc1
    s_sub_u32 s92, s92, 1
    s_cselect_b32 s7, -1, 0
    s_waitcnt vmcnt(0)
    v_cmp_ne_u32 vcc, 0, v4
    s_lshr_b32 s6, vcc_lo, 16
    s_and_b32 s6, s6, vcc_lo
    s_or_b32 s6, s6, s7
    s_and_b32 s62, s6, s66
    s_cbranch_scc0 FA_SMJ
    s_xor_b32 s66, s66, s62
    s_cselect_b32 s6, 0, 0xffff0000
    s_or_b32 s62, s62, s6
    s_branch FA_SRJ
FA_SLK:
    s_mov_b32 s92, 40000
FA_SMK:
    buffer_load_dword v4, v37, s[16:19], s68 offen sc1
    s_sub_u32 s92, s92, 1
    s_cselect_b32 s7, -1, 0
    s_waitcnt vmcnt(0)
    v_cmp_ne_u32 vcc, 0, v4
    s_lshr_b32 s6, vcc_lo, 16
    s_and_b32 s6, s6, vcc_lo
    s_or_b32 s6, s6, s7
    s_and_b32 s62, s6, s66
    s_cbranch_scc0 FA_SMK
    s_xor_b32 s66, s66, s62
    s_cselect_b32 s6, 0, 0xffff0000
    s_or_b32 s62, s62, s6
    s_branch FA_SRK
FA_SL1:
    s_mov_b32 s92, 40000
FA_SM1:
    buffer_load_dword v4, v37, s[16:19], s68 offen sc1
    s_sub_u32 s92, s92, 1
    s_cselect_b32 s7, -1, 0
    s_waitcnt vmcnt(0)
    v_cmp_ne_u32 vcc, 0, v4
    s_lshr_b32 s6, vcc_lo, 16
    s_and_b32 s6, s6, vcc_lo
    s_or_b32 s6, s6, s7
    s_and_b32 s62, s6, s66
    s_cbranch_scc0 FA_SM1
    s_xor_b32 s66, s66, s62
    s_cselect_b32 s6, 0, 0xffff0000
    s_or_b32 s62, s62, s6
    s_branch FA_SR1
FA_SL5:
    s_mov_b32 s92, 40000
FA_SM5:
    buffer_load_dword v4, v37, s[16:19], s68 offen sc1
    s_sub_u32 s92, s92, 1
    s_cselect_b32 s7, -1, 0
    s_waitcnt vmcnt(0)
    v_cmp_ne_u32 vcc, 0, v4
    s_lshr_b32 s6, vcc_lo, 16
    s_and_b32 s6, s6, vcc_lo
    s_or_b32 s6, s6, s7
    s_and_b32 s62, s6, s66
    s_cbranch_scc0 FA_SM5
    s_xor_b32 s66, s66, s62
    s_cselect_b32 s6, 0, 0xffff0000
    s_or_b32 s62, s62, s6
    s_branch FA_SR5
FA_RF:
    v_cmp_ne_u32 vcc, 0, v5
    s_lshr_b32 s6, vcc_lo, 16
    s_and_b32 s6, s6, vcc_lo
    s_and_b32 s6, s6, s66
    s_or_b32 s62, s62, s6
    s_xor_b32 s66, s66, s6
    s_cselect_b32 s6, 0, 0xffff0000
    s_or_b32 s62, s62, s6
    buffer_load_dword v5, v37, s[16:19], s68 offen nt
    s_branch FA_RG
.p2align 12
ST8:
    s_branch F_K1
FA_SL9:
    s_mov_b32 s92, 40000
FA_SM9:
    buffer_load_dword v4, v37, s[16:19], s68 offen sc1
    s_sub_u32 s92, s92, 1
    s_cselect_b32 s7, -1, 0
    s_waitcnt vmcnt(0)
    v_cmp_ne_u32 vcc, 0, v4
    s_lshr_b32 s6, vcc_lo, 16
    s_and_b32 s6, s6, vcc_lo
    s_or_b32 s6, s6, s7
    s_and_b32 s62, s6, s66
    s_cbranch_scc0 FA_SM9
    s_xor_b32 s66, s66, s62
    s_cselect_b32 s6, 0, 0xffff0000
    s_or_b32 s62, s62, s6
    s_branch FA_SR9
FA_SL13:
    s_mov_b32 s92, 40000
FA_SM13:
    buffer_load_dword v4, v37, s[16:19], s68 offen sc1
    s_sub_u32 s92, s92, 1
    s_cselect_b32 s7, -1, 0
    s_waitcnt vmcnt(0)
    v_cmp_ne_u32 vcc, 0, v4
    s_lshr_b32 s6, vcc_lo, 16
    s_and_b32 s6, s6, vcc_lo
    s_or_b32 s6, s6, s7
    s_and_b32 s62, s6, s66
    s_cbranch_scc0 FA_SM13
    s_xor_b32 s66, s66, s62
    s_cselect_b32 s6, 0, 0xffff0000
    s_or_b32 s62, s62, s6
    s_branch FA_SR13
.p2align 6
FA_LOOP:
    s_cmp_lt_u32 s58, 4
    s_cbranch_scc0 FA_A4
    s_setprio 3
FA_A4:
    v_exp_f32 v40, v40
    v_exp_f32 v41, v41
    v_smfmac_f32_32x32x32_bf16 v[136:151], v[16:19], v[64:71], v39
    s_mov_b64 exec, s[70:71]
    buffer_load_dwordx4 v[12:15], v2, s[16:19], s67 offen offset:1024 nt
    buffer_load_dwordx4 v[16:19], v2, s[16:19], s67 offen offset:1536 nt
    s_mov_b64 exec, -1
    v_exp_f32 v42, v42
    v_exp_f32 v43, v43
    v_exp_f32 v44, v44
    v_mfma_f32_32x32x16_bf16 v[56:71], v[20:23], v[76:79], 0
    v_exp_f32 v45, v45
    v_exp_f32 v46, v46
    v_exp_f32 v47, v47
    v_exp_f32 v48, v48
    v_exp_f32 v49, v49
    v_smfmac_f32_32x32x32_bf16 v[88:103], v[24:27], v[40:47], v39
    v_exp_f32 v50, v50
    v_exp_f32 v51, v51
    v_exp_f32 v52, v52
    v_exp_f32 v53, v53
    v_exp_f32 v54, v54
    v_exp_f32 v55, v55
    v_exp_f32 v56, v56
    v_exp_f32 v57, v57
    v_smfmac_f32_32x32x32_bf16 v[88:103], v[28:31], v[48:55], v39
    v_exp_f32 v58, v58
    v_exp_f32 v59, v59
    v_exp_f32 v60, v60
    v_mfma_f32_32x32x16_bf16 v[40:55], v[20:23], v[80:83], 0
    v_exp_f32 v61, v61
    v_exp_f32 v62, v62
    v_exp_f32 v63, v63
    v_exp_f32 v64, v64
    v_exp_f32 v65, v65
    v_smfmac_f32_32x32x32_bf16 v[104:119], v[24:27], v[56:63], v39
    v_exp_f32 v66, v66
    v_exp_f32 v67, v67
    s_cmp_eq_u32 s62, 0
    s_cbranch_scc1 FA_SL5
FA_SR5:
    s_ff1_i32_b32 s6, s62
    s_bitset0_b32 s62, s6
    s_lshl_b32 s6, s6, 11
    s_bitset0_b32 s6, 15
    s_xor_b32 s67, s64, s6
    v_exp_f32 v68, v68
    v_exp_f32 v69, v69
    v_exp_f32 v70, v70
    v_exp_f32 v71, v71
    v_exp_f32 v40, v40
    v_exp_f32 v41, v41
    v_smfmac_f32_32x32x32_bf16 v[104:119], v[28:31], v[64:71], v39
    v_exp_f32 v42, v42
    v_exp_f32 v43, v43
    v_exp_f32 v44, v44
    v_mfma_f32_32x32x16_bf16 v[56:71], v[20:23], v[84:87], 0
    buffer_load_dwordx4 v[20:23], v1, s[16:19], s67 offen nt
    v_exp_f32 v45, v45
    v_exp_f32 v46, v46
    v_exp_f32 v47, v47
    v_exp_f32 v48, v48
    v_exp_f32 v49, v49
    v_smfmac_f32_32x32x32_bf16 v[120:135], v[24:27], v[40:47], v39
    v_exp_f32 v50, v50
    v_exp_f32 v51, v51
    v_exp_f32 v52, v52
    v_exp_f32 v53, v53
    v_exp_f32 v54, v54
    v_exp_f32 v55, v55
    v_exp_f32 v56, v56
    v_exp_f32 v57, v57
    v_smfmac_f32_32x32x32_bf16 v[120:135], v[28:31], v[48:55], v39
    v_exp_f32 v58, v58
    v_exp_f32 v59, v59
    v_exp_f32 v60, v60
    s_waitcnt vmcnt(4)
    v_mfma_f32_32x32x16_bf16 v[40:55], v[152:155], v[72:75], 0
    v_exp_f32 v61, v61
    v_exp_f32 v62, v62
    v_exp_f32 v63, v63
    v_exp_f32 v64, v64
    v_exp_f32 v65, v65
    v_smfmac_f32_32x32x32_bf16 v[136:151], v[24:27], v[56:63], v39
    v_exp_f32 v66, v66
    v_exp_f32 v67, v67
    v_exp_f32 v68, v68
    v_exp_f32 v69, v69
    v_exp_f32 v70, v70
    v_exp_f32 v71, v71
    v_exp_f32 v40, v40
    v_exp_f32 v41, v41
    v_smfmac_f32_32x32x32_bf16 v[136:151], v[28:31], v[64:71], v39
    s_mov_b64 exec, s[70:71]
    buffer_load_dwordx4 v[24:27], v2, s[16:19], s67 offen offset:1024 nt
    buffer_load_dwordx4 v[28:31], v2, s[16:19], s67 offen offset:1536 nt
    s_mov_b64 exec, -1
    v_exp_f32 v42, v42
    v_exp_f32 v43, v43
    v_exp_f32 v44, v44
    v_mfma_f32_32x32x16_bf16 v[56:71], v[152:155], v[76:79], 0
    v_exp_f32 v45, v45
    v_exp_f32 v46, v46
    v_exp_f32 v47, v47
    v_exp_f32 v48, v48
    v_exp_f32 v49, v49
    v_smfmac_f32_32x32x32_bf16 v[88:103], v[156:159], v[40:47], v39
    v_exp_f32 v50, v50
    v_exp_f32 v51, v51
    s_cmp_lg_u32 s66, 0
    s_cbranch_scc1 FA_RF
FA_RG:
    v_exp_f32 v52, v52
    v_exp_f32 v53, v53
    v_exp_f32 v54, v54
    v_exp_f32 v55, v55
    v_exp_f32 v56, v56
    v_exp_f32 v57, v57
    v_smfmac_f32_32x32x32_bf16 v[88:103], v[160:163], v[48:55], v39
    v_exp_f32 v58, v58
    v_exp_f32 v59, v59
    v_exp_f32 v60, v60
    v_mfma_f32_32x32x16_bf16 v[40:55], v[152:155], v[80:83], 0
    v_exp_f32 v61, v61
    v_exp_f32 v62, v62
    v_exp_f32 v63, v63
    v_exp_f32 v64, v64
    v_exp_f32 v65, v65
    v_smfmac_f32_32x32x32_bf16 v[104:119], v[156:159], v[56:63], v39
    v_exp_f32 v66, v66
    v_exp_f32 v67, v67
    s_cmp_eq_u32 s62, 0
    s_cbranch_scc1 FA_SL9
FA_SR9:
    s_ff1_i32_b32 s6, s62
    s_bitset0_b32 s62, s6
    s_lshl_b32 s6, s6, 11
    s_bitset0_b32 s6, 15
    s_xor_b32 s67, s64, s6
    v_exp_f32 v68, v68
    v_exp_f32 v69, v69
    v_exp_f32 v70, v70
    v_exp_f32 v71, v71
    v_exp_f32 v40, v40
    v_exp_f32 v41, v41
    v_smfmac_f32_32x32x32_bf16 v[104:119], v[160:163], v[64:71], v39
    v_exp_f32 v42, v42
    v_exp_f32 v43, v43
    v_exp_f32 v44, v44
    v_mfma_f32_32x32x16_bf16 v[56:71], v[152:155], v[84:87], 0
    buffer_load_dwordx4 v[152:155], v1, s[16:19], s67 offen nt
    v_exp_f32 v45, v45
    v_exp_f32 v46, v46
    v_exp_f32 v47, v47
    v_exp_f32 v48, v48
    v_exp_f32 v49, v49
    v_smfmac_f32_32x32x32_bf16 v[120:135], v[156:159], v[40:47], v39
    v_exp_f32 v50, v50
    v_exp_f32 v51, v51
    v_exp_f32 v52, v52
    v_exp_f32 v53, v53
    v_exp_f32 v54, v54
    v_exp_f32 v55, v55
    v_exp_f32 v56, v56
    v_exp_f32 v57, v57
    v_smfmac_f32_32x32x32_bf16 v[120:135], v[160:163], v[48:55], v39
    v_exp_f32 v58, v58
    v_exp_f32 v59, v59
    v_exp_f32 v60, v60
    s_waitcnt vmcnt(4)
    v_mfma_f32_32x32x16_bf16 v[40:55], v[8:11], v[72:75], 0
    v_exp_f32 v61, v61
    v_exp_f32 v62, v62
    v_exp_f32 v63, v63
    v_exp_f32 v64, v64
    v_exp_f32 v65, v65
    v_smfmac_f32_32x32x32_bf16 v[136:151], v[156:159], v[56:63], v39
    v_exp_f32 v66, v66
    v_exp_f32 v67, v67
    v_exp_f32 v68, v68
    v_exp_f32 v69, v69
    v_exp_f32 v70, v70
    v_exp_f32 v71, v71
    v_exp_f32 v40, v40
    v_exp_f32 v41, v41
    v_smfmac_f32_32x32x32_bf16 v[136:151], v[160:163], v[64:71], v39
    s_mov_b64 exec, s[70:71]
    buffer_load_dwordx4 v[156:159], v2, s[16:19], s67 offen offset:1024 nt
    buffer_load_dwordx4 v[160:163], v2, s[16:19], s67 offen offset:1536 nt
    s_mov_b64 exec, -1
    v_exp_f32 v42, v42
    v_exp_f32 v43, v43
    v_exp_f32 v44, v44
    s_branch SK9
ST9:
    s_branch F_K1
SK9:
    v_mfma_f32_32x32x16_bf16 v[56:71], v[8:11], v[76:79], 0
    v_exp_f32 v45, v45
    v_exp_f32 v46, v46
    v_exp_f32 v47, v47
    v_exp_f32 v48, v48
    v_exp_f32 v49, v49
    v_smfmac_f32_32x32x32_bf16 v[88:103], v[12:15], v[40:47], v39
    v_exp_f32 v50, v50
    v_exp_f32 v51, v51
    v_exp_f32 v52, v52
    v_exp_f32 v53, v53
    v_exp_f32 v54, v54
    v_exp_f32 v55, v55
    v_exp_f32 v56, v56
    v_exp_f32 v57, v57
    v_smfmac_f32_32x32x32_bf16 v[88:103], v[16:19], v[48:55], v39
    v_exp_f32 v58, v58
    v_exp_f32 v59, v59
    v_exp_f32 v60, v60
    v_mfma_f32_32x32x16_bf16 v[40:55], v[8:11], v[80:83], 0
    v_exp_f32 v61, v61
    v_exp_f32 v62, v62
    v_exp_f32 v63, v63
    v_exp_f32 v64, v64
    v_exp_f32 v65, v65
    v_smfmac_f32_32x32x32_bf16 v[104:119], v[12:15], v[56:63], v39
    v_exp_f32 v66, v66
    v_exp_f32 v67, v67
    s_cmp_eq_u32 s62, 0
    s_cbranch_scc1 FA_SL13
FA_SR13:
    s_ff1_i32_b32 s6, s62
    s_bitset0_b32 s62, s6
    s_lshl_b32 s6, s6, 11
    s_bitset0_b32 s6, 15
    s_xor_b32 s67, s64, s6
    v_exp_f32 v68, v68
    v_exp_f32 v69, v69
    v_exp_f32 v70, v70
    v_exp_f32 v71, v71
    s_cmp_lt_u32 s58, 4
    s_cbranch_scc0 FA_A14
    s_setprio 1
FA_A14:
    v_exp_f32 v40, v40
    v_exp_f32 v41, v41
    v_smfmac_f32_32x32x32_bf16 v[104:119], v[16:19], v[64:71], v39
    v_exp_f32 v42, v42
    v_exp_f32 v43, v43
    v_exp_f32 v44, v44
    v_mfma_f32_32x32x16_bf16 v[56:71], v[8:11], v[84:87], 0
    buffer_load_dwordx4 v[8:11], v1, s[16:19], s67 offen nt
    v_exp_f32 v45, v45
    v_exp_f32 v46, v46
    v_exp_f32 v47, v47
    v_exp_f32 v48, v48
    v_exp_f32 v49, v49
    v_smfmac_f32_32x32x32_bf16 v[120:135], v[12:15], v[40:47], v39
    v_exp_f32 v50, v50
    v_exp_f32 v51, v51
    v_exp_f32 v52, v52
    v_exp_f32 v53, v53
    v_exp_f32 v54, v54
    v_exp_f32 v55, v55
    v_exp_f32 v56, v56
    v_exp_f32 v57, v57
    v_smfmac_f32_32x32x32_bf16 v[120:135], v[16:19], v[48:55], v39
    v_exp_f32 v58, v58
    v_exp_f32 v59, v59
    v_exp_f32 v60, v60
    s_waitcnt vmcnt(4)
    v_mfma_f32_32x32x16_bf16 v[40:55], v[20:23], v[72:75], 0
    v_exp_f32 v61, v61
    v_exp_f32 v62, v62
    v_exp_f32 v63, v63
    v_exp_f32 v64, v64
    v_exp_f32 v65, v65
    v_smfmac_f32_32x32x32_bf16 v[136:151], v[12:15], v[56:63], v39
    v_exp_f32 v66, v66
    v_exp_f32 v67, v67
    s_add_u32 s69, s69, 1
    s_cmp_lg_u32 s69, 5
    v_exp_f32 v68, v68
    v_exp_f32 v69, v69
    v_exp_f32 v70, v70
    v_exp_f32 v71, v71
    s_cbranch_scc1 FA_LOOP
    s_setprio 3
    v_smfmac_f32_32x32x32_bf16 v[136:151], v[16:19], v[64:71], v39
    s_lshl_b32 s6, s82, 2
    v_add_u32 v4, s6, v164
    s_mov_b64 exec, 1
    ds_add_u32 v4, v165 offset:7752
    s_mov_b64 exec, -1
    s_mul_i32 s6, s82, 100
    v_add_u32 v5, s6, v164
    v_lshlrev_b32 v6, 2, v0
    s_cmp_eq_u32 s82, 0
    s_cselect_b32 s76, 12, 4
    s_mov_b32 s7, 131072
    s_movk_i32 s75, 6912
    s_mov_b32 s92, 320000
LL_21:
    ds_read_b32 v4, v5 offset:7692
    s_waitcnt lgkmcnt(0)
    v_readfirstlane_b32 s93, v4
    s_cmp_ge_u32 s93, s76
    s_cbranch_scc1 LD_22
    s_sleep 1
    s_sub_u32 s92, s92, 1
    s_cmp_lg_u32 s92, 0
    s_cbranch_scc1 LL_21
LD_22:
    s_xor_b32 s6, s74, 1
    s_mul_i32 s6, s6, s75
    s_add_u32 s6, s6, s7
    v_add_u32 v4, s6, v1
    v_add_u32 v5, s6, v6
    ds_write_b128 v4, v[104:107] offset:0
    ds_write_b128 v4, v[108:111] offset:1024
    ds_write_b32 v5, v112 offset:2048
    s_xor_b32 s6, s74, 2
    s_mul_i32 s6, s6, s75
    s_add_u32 s6, s6, s7
    v_add_u32 v4, s6, v1
    v_add_u32 v5, s6, v6
    ds_write_b128 v4, v[120:123] offset:2304
    ds_write_b128 v4, v[124:127] offset:3328
    ds_write_b32 v5, v128 offset:4352
    s_xor_b32 s6, s74, 3
    s_mul_i32 s6, s6, s75
    s_add_u32 s6, s6, s7
    v_add_u32 v4, s6, v1
    v_add_u32 v5, s6, v6
    ds_write_b128 v4, v[136:139] offset:4608
    ds_write_b128 v4, v[140:143] offset:5632
    ds_write_b32 v5, v144 offset:6656
    s_mov_b64 exec, 7
    ds_add_u32 v3, v165 offset:7712
    s_mov_b64 exec, -1
    s_mul_i32 s6, s74, s75
    s_add_u32 s6, s6, s7
    v_add_u32 v32, s6, v1
    v_add_u32 v5, s6, v6
    s_mov_b32 s92, 320000
LL_23:
    ds_read_b32 v4, v7 offset:7712
    s_waitcnt lgkmcnt(0)
    v_readfirstlane_b32 s93, v4
    s_cmp_ge_u32 s93, 3
    s_cbranch_scc1 LD_24
    s_sleep 1
    s_sub_u32 s92, s92, 1
    s_cmp_lg_u32 s92, 0
    s_cbranch_scc1 LL_23
LD_24:
    ds_read_b128 v[104:107], v32 offset:0
    ds_read_b128 v[108:111], v32 offset:1024
    ds_read_b32 v112, v5 offset:2048
    ds_read_b128 v[120:123], v32 offset:2304
    ds_read_b128 v[124:127], v32 offset:3328
    ds_read_b32 v128, v5 offset:4352
    ds_read_b128 v[136:139], v32 offset:4608
    ds_read_b128 v[140:143], v32 offset:5632
    ds_read_b32 v144, v5 offset:6656
    s_waitcnt lgkmcnt(6)
    v_add_f32 v88, v88, v104
    v_add_f32 v89, v89, v105
    v_add_f32 v90, v90, v106
    v_add_f32 v91, v91, v107
    v_add_f32 v92, v92, v108
    v_add_f32 v93, v93, v109
    v_add_f32 v94, v94, v110
    v_add_f32 v95, v95, v111
    v_add_f32 v96, v96, v112
    s_waitcnt lgkmcnt(3)
    v_add_f32 v88, v88, v120
    v_add_f32 v89, v89, v121
    v_add_f32 v90, v90, v122
    v_add_f32 v91, v91, v123
    v_add_f32 v92, v92, v124
    v_add_f32 v93, v93, v125
    v_add_f32 v94, v94, v126
    v_add_f32 v95, v95, v127
    v_add_f32 v96, v96, v128
    s_waitcnt lgkmcnt(0)
    v_add_f32 v88, v88, v136
    v_add_f32 v89, v89, v137
    v_add_f32 v90, v90, v138
    v_add_f32 v91, v91, v139
    v_add_f32 v92, v92, v140
    v_add_f32 v93, v93, v141
    v_add_f32 v94, v94, v142
    v_add_f32 v95, v95, v143
    v_add_f32 v96, v96, v144
    s_lshl_b32 s6, s82, 2
    v_add_u32 v4, s6, v164
    s_mov_b64 exec, 1
    ds_add_u32 v4, v165 offset:7792
    s_mov_b64 exec, -1
    v_mov_b32 v4, v96
    v_fmac_f32 v4, 0, v88
    v_fmac_f32 v4, 0, v89
    v_fmac_f32 v4, 0, v90
    v_fmac_f32 v4, 0, v91
    v_fmac_f32 v4, 0, v92
    v_fmac_f32 v4, 0, v93
    v_fmac_f32 v4, 0, v94
    v_fmac_f32 v4, 0, v95
    s_mov_b32 s93, 0x71800000
    v_cmp_le_f32 vcc, 0x0d800000, v4
    v_cmp_ge_f32 s[94:95], s93, v4
    s_and_b64 vcc, vcc, s[94:95]
    s_cmp_eq_u64 vcc, -1
    s_cbranch_scc0 FA_FB
FA_NORM:
    v_rcp_f32 v4, v96
    s_nop 0
    v_mul_f32 v88, v88, v4
    v_mul_f32 v89, v89, v4
    v_mul_f32 v90, v90, v4
    v_mul_f32 v91, v91, v4
    v_mul_f32 v92, v92, v4
    v_mul_f32 v93, v93, v4
    v_mul_f32 v94, v94, v4
    v_mul_f32 v95, v95, v4
    v_cvt_pk_bf16_f32 v88, v88, v89
    v_cvt_pk_bf16_f32 v89, v90, v91
    v_cvt_pk_bf16_f32 v90, v92, v93
    v_cvt_pk_bf16_f32 v91, v94, v95
    buffer_store_dwordx4 v[88:91], v1, s[16:19], s85 offen sc1
    s_endpgm
ST10:
    s_branch F_K1
F_A:
    s_setprio 2
    s_sub_u32 s58, s3, 4
    s_mov_b32 s35, 0xffff0000
    s_lshr_b32 s82, s58, 2
    s_lshl1_add_u32 s84, s33, s82
    s_lshl2_add_u32 s6, s32, s74
    s_lshl_b32 s85, s6, 15
    s_lshl_b32 s7, s84, 10
    s_add_u32 s85, s85, s7
    s_add_u32 s85, s85, 16777216
    v_mov_b32 v165, 1
    v_mov_b32 v164, 155648
    v_and_b32 v162, 15, v0
    v_lshlrev_b32 v162, 4, v162
    v_lshrrev_b32 v9, 5, v0
    v_lshl_add_u32 v162, v9, 8, v162
    s_mov_b32 s24, s54
    s_mov_b32 s25, s55
    s_mov_b32 s26, 256
    s_mov_b32 s27, 0x00020000
    v_lshrrev_b32 v9, 5, v0
    v_bfe_u32 v10, v0, 2, 2
    v_lshl_add_u32 v9, v9, 3, v10
    v_lshlrev_b32 v6, 7, v9
    v_bfe_u32 v9, v0, 3, 1
    v_lshl_add_u32 v6, v9, 6, v6
    v_and_b32 v9, 16, v0
    v_lshl_add_u32 v6, v9, 1, v6
    v_and_b32 v9, 3, v0
    v_lshl_add_u32 v6, v9, 3, v6
    v_add_u32 v6, 65536, v6
    v_lshrrev_b32 v9, 5, v0
    v_bfe_u32 v10, v0, 2, 2
    v_lshl_add_u32 v9, v9, 3, v10
    v_lshlrev_b32 v8, 6, v9
    v_and_b32 v9, 16, v0
    v_lshl_add_u32 v8, v9, 1, v8
    v_and_b32 v9, 3, v0
    v_lshl_add_u32 v8, v9, 3, v8
    v_add_u32 v8, 73728, v8
    v_lshrrev_b32 v9, 2, v0
    v_xor_b32 v9, v9, v0
    v_and_b32 v9, 4, v9
    v_and_b32 v10, 3, v0
    v_or_b32 v9, v9, v10
    v_cmp_eq_u32 vcc, 0, v9
    v_mov_b32 v10, 0x3f803f80
    s_nop 0
    v_cndmask_b32 v40, 0, v10, vcc
    v_mov_b32 v41, v40
    v_mov_b32 v42, v40
    v_mov_b32 v43, v40
    v_and_b32 v11, 31, v0
    v_lshl_add_u32 v13, v11, 4, v164
    v_mov_b32 v18, 0
    v_mov_b32 v19, 0
    v_mov_b32 v20, 0
    v_mov_b32 v21, 0
    v_mov_b32 v22, 0
    v_mov_b32 v23, 0
    v_mov_b32 v24, 0
    v_mov_b32 v25, 0
    v_mov_b32 v26, 0
    v_mov_b32 v27, 0
    v_mov_b32 v28, 0
    v_mov_b32 v29, 0
    s_mov_b32 s16, s56
    s_mov_b32 s17, s57
    s_mov_b32 s18, 268435456
    s_mov_b32 s19, 0x00020000
    s_lshl_b32 s6, s74, 11
    v_add_u32 v6, s6, v6
    v_xor_b32 v7, 64, v6
    s_lshl_b32 s6, s74, 10
    v_add_u32 v8, s6, v8
    s_lshl_b32 s6, s74, 2
    v_add_u32 v13, s6, v13
    s_cmp_eq_u32 s58, 7
    s_cselect_b32 s6, 0, 256
    v_and_b32 v78, 7, v0
    v_lshl_add_u32 v78, v78, 5, s6
    s_add_u32 s66, s34, 1
    s_and_b32 s66, s66, 7
    s_lshl_b32 s67, s66, 7
    s_add_u32 m0, s61, 16384
    s_add_u32 s67, s67, s60
    buffer_load_dwordx4 v140, s[8:11], s67 offen offset:0 lds
    buffer_load_dwordx4 v141, s[8:11], s67 offen offset:1024 lds
    buffer_load_dwordx4 v142, s[8:11], s67 offen offset:2048 lds
    buffer_load_dwordx4 v143, s[8:11], s67 offen offset:3072 lds
    s_mov_b32 s28, s44
    s_mov_b32 s29, s45
    s_mov_b32 s30, 1835008
    s_mov_b32 s31, 0x00020000
    s_mov_b32 s20, s46
    s_mov_b32 s21, s47
    s_mov_b32 s22, 3584
    s_mov_b32 s23, 0x00020000
    s_lshr_b32 s6, s33, 2
    s_mul_i32 s6, s6, 896
    s_and_b32 s7, s33, 3
    s_lshl_b32 s68, s7, 7
    s_add_u32 s68, s68, s6
    s_cmp_lg_u32 s7, 3
    s_cselect_b32 s89, 1, 0
    s_cselect_b32 s69, 0, 16777216
    s_lshr_b32 s86, s74, 1
    s_add_u32 s86, s86, s34
    s_and_b32 s87, s74, 1
    s_mul_i32 s87, s87, 114688
    s_add_u32 s87, s87, s68
    s_lshl_b32 s88, s74, 12
    v_lshrrev_b32 v9, 3, v0
    v_mul_u32_u24 v68, 3584, v9
    v_lshrrev_b32 v9, 2, v0
    v_and_b32 v9, 4, v9
    v_xor_b32 v9, v9, v0
    v_and_b32 v9, 7, v9
    v_lshl_add_u32 v68, v9, 4, v68
    v_add_u32 v73, s69, v68
    s_lshr_b32 s6, s74, 1
    s_lshl_b32 s6, s6, 12
    s_add_u32 s6, s6, s68
    v_lshl_add_u32 v71, v0, 1, s6
    v_lshrrev_b32 v9, 5, v0
    v_bfe_u32 v10, v0, 2, 2
    v_lshl_add_u32 v9, v9, 3, v10
    v_lshlrev_b32 v69, 7, v9
    v_bfe_u32 v9, v0, 3, 1
    v_lshl_add_u32 v69, v9, 6, v69
    v_and_b32 v9, 16, v0
    v_lshl_add_u32 v69, v9, 1, v69
    v_and_b32 v9, 3, v0
    v_lshl_add_u32 v69, v9, 3, v69
    v_add_u32 v69, s88, v69
    v_xor_b32 v70, 64, v69
    s_lshr_b32 s6, s74, 1
    s_lshl_b32 s6, s6, 9
    s_and_b32 s7, s74, 1
    s_lshl3_add_u32 s6, s7, s6
    s_add_u32 s6, s6, 143360
    v_and_b32 v9, 0x200, v1
    v_add3_u32 v74, v9, v1, s6
    v_mov_b32 v75, 0x100
    v_mov_b32 v76, -1
    v_mov_b32 v77, -1
    s_waitcnt vmcnt(4)
    s_barrier
    ds_read_b64_tr_b16 v[86:87], v6 offset:0
    ds_read_b64_tr_b16 v[88:89], v6 offset:512
    ds_read_b64_tr_b16 v[90:91], v7 offset:0
    ds_read_b64_tr_b16 v[92:93], v7 offset:512
    ds_read_b64_tr_b16 v[94:95], v8 offset:0
    ds_read_b64_tr_b16 v[96:97], v8 offset:256
    s_add_u32 s66, s34, 2
    s_and_b32 s66, s66, 7
    s_lshl_b32 s67, s66, 7
    s_add_u32 m0, s61, 32768
    s_add_u32 s67, s67, s60
    buffer_load_dwordx4 v140, s[8:11], s67 offen offset:0 lds
    buffer_load_dwordx4 v141, s[8:11], s67 offen offset:1024 lds
    buffer_load_dwordx4 v142, s[8:11], s67 offen offset:2048 lds
    buffer_load_dwordx4 v143, s[8:11], s67 offen offset:3072 lds
    s_waitcnt lgkmcnt(4)
    v_mfma_f32_16x16x32_bf16 v[18:21], v[40:43], v[86:89], v[18:21]
    s_waitcnt lgkmcnt(2)
    v_mfma_f32_16x16x32_bf16 v[22:25], v[40:43], v[90:93], v[22:25]
    s_waitcnt lgkmcnt(0)
    v_mfma_f32_16x16x32_bf16 v[26:29], v[40:43], v[94:97], v[26:29]
    s_waitcnt vmcnt(4)
    s_barrier
    ds_read_b64_tr_b16 v[86:87], v6 offset:16384
    ds_read_b64_tr_b16 v[88:89], v6 offset:16896
    ds_read_b64_tr_b16 v[90:91], v7 offset:16384
    ds_read_b64_tr_b16 v[92:93], v7 offset:16896
    ds_read_b64_tr_b16 v[94:95], v8 offset:16384
    ds_read_b64_tr_b16 v[96:97], v8 offset:16640
    s_add_u32 s66, s34, 3
    s_and_b32 s66, s66, 7
    s_lshl_b32 s67, s66, 7
    s_add_u32 m0, s61, 49152
    s_add_u32 s67, s67, s60
    buffer_load_dwordx4 v140, s[8:11], s67 offen offset:0 lds
    buffer_load_dwordx4 v141, s[8:11], s67 offen offset:1024 lds
    buffer_load_dwordx4 v142, s[8:11], s67 offen offset:2048 lds
    buffer_load_dwordx4 v143, s[8:11], s67 offen offset:3072 lds
    s_waitcnt lgkmcnt(4)
    v_mfma_f32_16x16x32_bf16 v[18:21], v[40:43], v[86:89], v[18:21]
    s_waitcnt lgkmcnt(2)
    v_mfma_f32_16x16x32_bf16 v[22:25], v[40:43], v[90:93], v[22:25]
    s_waitcnt lgkmcnt(0)
    v_mfma_f32_16x16x32_bf16 v[26:29], v[40:43], v[94:97], v[26:29]
    s_waitcnt vmcnt(4)
    s_barrier
    ds_read_b64_tr_b16 v[86:87], v6 offset:32768
    s_branch SK11
ST11:
    s_branch F_K1
SK11:
    ds_read_b64_tr_b16 v[88:89], v6 offset:33280
    ds_read_b64_tr_b16 v[90:91], v7 offset:32768
    ds_read_b64_tr_b16 v[92:93], v7 offset:33280
    ds_read_b64_tr_b16 v[94:95], v8 offset:32768
    ds_read_b64_tr_b16 v[96:97], v8 offset:33024
    s_add_u32 s66, s34, 4
    s_and_b32 s66, s66, 7
    s_lshl_b32 s67, s66, 7
    s_add_u32 m0, s61, 65536
    s_add_u32 s67, s67, s60
    buffer_load_dwordx4 v140, s[8:11], s67 offen offset:0 lds
    buffer_load_dwordx4 v141, s[8:11], s67 offen offset:1024 lds
    buffer_load_dwordx4 v142, s[8:11], s67 offen offset:2048 lds
    buffer_load_dwordx4 v143, s[8:11], s67 offen offset:3072 lds
    s_waitcnt lgkmcnt(4)
    v_mfma_f32_16x16x32_bf16 v[18:21], v[40:43], v[86:89], v[18:21]
    s_waitcnt lgkmcnt(2)
    v_mfma_f32_16x16x32_bf16 v[22:25], v[40:43], v[90:93], v[22:25]
    s_waitcnt lgkmcnt(0)
    v_mfma_f32_16x16x32_bf16 v[26:29], v[40:43], v[94:97], v[26:29]
    s_waitcnt vmcnt(4)
    s_barrier
    ds_read_b64_tr_b16 v[86:87], v6 offset:49152
    ds_read_b64_tr_b16 v[88:89], v6 offset:49664
    ds_read_b64_tr_b16 v[90:91], v7 offset:49152
    ds_read_b64_tr_b16 v[92:93], v7 offset:49664
    ds_read_b64_tr_b16 v[94:95], v8 offset:49152
    ds_read_b64_tr_b16 v[96:97], v8 offset:49408
    s_add_u32 s66, s34, 5
    s_and_b32 s66, s66, 7
    s_lshl_b32 s67, s66, 7
    s_add_u32 m0, s61, 81920
    s_add_u32 s67, s67, s60
    buffer_load_dwordx4 v140, s[8:11], s67 offen offset:0 lds
    buffer_load_dwordx4 v141, s[8:11], s67 offen offset:1024 lds
    buffer_load_dwordx4 v142, s[8:11], s67 offen offset:2048 lds
    buffer_load_dwordx4 v143, s[8:11], s67 offen offset:3072 lds
    s_lshl2_add_u32 s6, s32, s74
    s_mul_i32 s6, s6, 28672
    s_add_u32 s6, s6, s68
    v_and_b32 v9, 7, v0
    v_mul_u32_u24 v4, 3584, v9
    v_and_b32 v9, 8, v0
    v_lshl_add_u32 v4, v9, 6, v4
    v_add_u32 v4, s6, v4
    s_mov_b64 exec, 0xffff
    buffer_load_dword v3, v4, s[28:31], 0 offen
    s_mov_b64 exec, -1
    s_waitcnt lgkmcnt(4)
    v_mfma_f32_16x16x32_bf16 v[18:21], v[40:43], v[86:89], v[18:21]
    s_waitcnt lgkmcnt(2)
    v_mfma_f32_16x16x32_bf16 v[22:25], v[40:43], v[90:93], v[22:25]
    s_waitcnt lgkmcnt(0)
    v_mfma_f32_16x16x32_bf16 v[26:29], v[40:43], v[94:97], v[26:29]
    buffer_load_ushort v72, v71, s[20:23], 0 offen
    buffer_load_ushort v71, v71, s[20:23], 0 offen offset:512
    s_waitcnt vmcnt(7)
    s_barrier
    v_add_u32 v6, 0xffff0000, v6
    v_add_u32 v7, 0xffff0000, v7
    v_add_u32 v8, 0xffff0000, v8
    ds_read_b64_tr_b16 v[86:87], v6 offset:0
    ds_read_b64_tr_b16 v[88:89], v6 offset:512
    ds_read_b64_tr_b16 v[90:91], v7 offset:0
    ds_read_b64_tr_b16 v[92:93], v7 offset:512
    ds_read_b64_tr_b16 v[94:95], v8 offset:0
    ds_read_b64_tr_b16 v[96:97], v8 offset:256
    s_add_u32 s66, s34, 6
    s_and_b32 s66, s66, 7
    s_lshl_b32 s67, s66, 7
    s_add_u32 m0, s61, 98304
    s_add_u32 s67, s67, s60
    buffer_load_dwordx4 v140, s[8:11], s67 offen offset:0 lds
    buffer_load_dwordx4 v141, s[8:11], s67 offen offset:1024 lds
    buffer_load_dwordx4 v142, s[8:11], s67 offen offset:2048 lds
    buffer_load_dwordx4 v143, s[8:11], s67 offen offset:3072 lds
    s_waitcnt lgkmcnt(4)
    v_mfma_f32_16x16x32_bf16 v[18:21], v[40:43], v[86:89], v[18:21]
    s_waitcnt lgkmcnt(2)
    v_mfma_f32_16x16x32_bf16 v[22:25], v[40:43], v[90:93], v[22:25]
    s_waitcnt lgkmcnt(0)
    v_mfma_f32_16x16x32_bf16 v[26:29], v[40:43], v[94:97], v[26:29]
    s_waitcnt vmcnt(7)
    s_barrier
    v_add_u32 v6, 0x20000, v6
    v_add_u32 v7, 0x20000, v7
    v_add_u32 v8, 0x20000, v8
    ds_read_b64_tr_b16 v[86:87], v6 offset:0
    ds_read_b64_tr_b16 v[88:89], v6 offset:512
    ds_read_b64_tr_b16 v[90:91], v7 offset:0
    ds_read_b64_tr_b16 v[92:93], v7 offset:512
    ds_read_b64_tr_b16 v[94:95], v8 offset:0
    ds_read_b64_tr_b16 v[96:97], v8 offset:256
    s_add_u32 s66, s34, 7
    s_and_b32 s66, s66, 7
    s_lshl_b32 s67, s66, 7
    s_add_u32 m0, s61, 114688
    s_add_u32 s67, s67, s60
    buffer_load_dwordx4 v140, s[8:11], s67 offen offset:0 lds
    buffer_load_dwordx4 v141, s[8:11], s67 offen offset:1024 lds
    buffer_load_dwordx4 v142, s[8:11], s67 offen offset:2048 lds
    buffer_load_dwordx4 v143, s[8:11], s67 offen offset:3072 lds
    s_waitcnt lgkmcnt(4)
    v_mfma_f32_16x16x32_bf16 v[18:21], v[40:43], v[86:89], v[18:21]
    s_waitcnt lgkmcnt(2)
    v_mfma_f32_16x16x32_bf16 v[22:25], v[40:43], v[90:93], v[22:25]
    s_waitcnt lgkmcnt(0)
    v_mfma_f32_16x16x32_bf16 v[26:29], v[40:43], v[94:97], v[26:29]
    s_waitcnt vmcnt(4)
    s_mov_b64 exec, 1
    ds_add_u32 v164, v165 offset:7800
    s_mov_b64 exec, -1
    s_add_u32 s7, s86, 0
    s_and_b32 s7, s7, 7
    s_mul_i32 s69, s7, 229376
    s_add_u32 s69, s69, s87
    s_add_u32 m0, s88, 0
    s_add_u32 s6, s69, 0
    buffer_load_dwordx4 v68, s[28:31], s6 offen offset:0 lds
    s_add_u32 m0, s88, 0
    s_add_u32 s6, s69, 27648
    buffer_load_dwordx4 v68, s[28:31], s6 offen offset:1024 lds
    s_add_u32 m0, s88, 2048
    s_branch SK12
.p2align 12
ST12:
    s_branch F_K1
SK12:
    s_add_u32 s6, s69, 57344
    buffer_load_dwordx4 v68, s[28:31], s6 offen offset:0 lds
    s_add_u32 m0, s88, 2048
    s_add_u32 s6, s69, 84992
    buffer_load_dwordx4 v68, s[28:31], s6 offen offset:1024 lds
    s_waitcnt vmcnt(4)
    s_mov_b64 exec, 1
    ds_add_u32 v164, v75 offset:7800
    s_mov_b64 exec, -1
    s_add_u32 s7, s86, 2
    s_and_b32 s7, s7, 7
    s_mul_i32 s69, s7, 229376
    s_add_u32 s69, s69, s87
    s_add_u32 m0, s88, 16384
    s_add_u32 s6, s69, 0
    buffer_load_dwordx4 v68, s[28:31], s6 offen offset:0 lds
    s_add_u32 m0, s88, 16384
    s_add_u32 s6, s69, 27648
    buffer_load_dwordx4 v68, s[28:31], s6 offen offset:1024 lds
    s_add_u32 m0, s88, 18432
    s_add_u32 s6, s69, 57344
    buffer_load_dwordx4 v68, s[28:31], s6 offen offset:0 lds
    s_add_u32 m0, s88, 18432
    s_add_u32 s6, s69, 84992
    buffer_load_dwordx4 v68, s[28:31], s6 offen offset:1024 lds
    s_mov_b32 s92, 320000
LL_25:
    ds_read_b32 v9, v164 offset:7800
    s_waitcnt lgkmcnt(0)
    v_readfirstlane_b32 s93, v9
    s_bitcmp1_b32 s93, 11
    s_cbranch_scc1 LD_26
    s_sleep 1
    s_sub_u32 s92, s92, 1
    s_cmp_lg_u32 s92, 0
    s_cbranch_scc1 LL_25
LD_26:
    ds_read_b64_tr_b16 v[86:87], v6 offset:12288
    ds_read_b64_tr_b16 v[88:89], v6 offset:12800
    ds_read_b64_tr_b16 v[90:91], v7 offset:12288
    ds_read_b64_tr_b16 v[92:93], v7 offset:12800
    ds_read_b64_tr_b16 v[94:95], v8 offset:12288
    ds_read_b64_tr_b16 v[96:97], v8 offset:12544
    v_add_u32 v6, 0xffff0000, v6
    v_add_u32 v7, 0xffff0000, v7
    v_add_u32 v8, 0xffff0000, v8
    ds_read_b64_tr_b16 v[98:99], v6 offset:0
    ds_read_b64_tr_b16 v[100:101], v6 offset:512
    ds_read_b64_tr_b16 v[102:103], v7 offset:0
    ds_read_b64_tr_b16 v[104:105], v7 offset:512
    ds_read_b64_tr_b16 v[106:107], v8 offset:0
    ds_read_b64_tr_b16 v[108:109], v8 offset:256
    s_waitcnt lgkmcnt(10)
    v_mfma_f32_16x16x32_bf16 v[18:21], v[40:43], v[86:89], v[18:21]
    s_waitcnt lgkmcnt(8)
    v_mfma_f32_16x16x32_bf16 v[22:25], v[40:43], v[90:93], v[22:25]
    s_waitcnt lgkmcnt(6)
    v_mfma_f32_16x16x32_bf16 v[26:29], v[40:43], v[94:97], v[26:29]
    s_waitcnt lgkmcnt(4)
    v_mfma_f32_16x16x32_bf16 v[18:21], v[40:43], v[98:101], v[18:21]
    s_waitcnt lgkmcnt(2)
    v_mfma_f32_16x16x32_bf16 v[22:25], v[40:43], v[102:105], v[22:25]
    s_waitcnt lgkmcnt(0)
    v_mfma_f32_16x16x32_bf16 v[26:29], v[40:43], v[106:109], v[26:29]
    s_nop 3
    ds_write_b32 v13, v18 offset:0
    s_nop 0
    ds_write_b32 v13, v22 offset:512
    s_nop 0
    ds_write_b32 v13, v26 offset:1024
    s_mov_b64 exec, 1
    ds_add_u32 v164, v165 offset:7700
    s_mov_b64 exec, -1
    s_add_u32 s7, s86, 4
    s_and_b32 s7, s7, 7
    s_mul_i32 s69, s7, 229376
    s_add_u32 s69, s69, s87
    s_add_u32 m0, s88, 32768
    s_add_u32 s6, s69, 0
    buffer_load_dwordx4 v68, s[28:31], s6 offen offset:0 lds
    s_add_u32 m0, s88, 32768
    s_add_u32 s6, s69, 27648
    buffer_load_dwordx4 v68, s[28:31], s6 offen offset:1024 lds
    s_add_u32 m0, s88, 34816
    s_add_u32 s6, s69, 57344
    buffer_load_dwordx4 v68, s[28:31], s6 offen offset:0 lds
    s_add_u32 m0, s88, 34816
    s_add_u32 s6, s69, 84992
    buffer_load_dwordx4 v68, s[28:31], s6 offen offset:1024 lds
    s_add_u32 s7, s86, 6
    s_and_b32 s7, s7, 7
    s_mul_i32 s69, s7, 229376
    s_add_u32 s69, s69, s87
    s_add_u32 m0, s88, 49152
    s_add_u32 s6, s69, 0
    buffer_load_dwordx4 v68, s[28:31], s6 offen offset:0 lds
    s_add_u32 m0, s88, 49152
    s_add_u32 s6, s69, 27648
    buffer_load_dwordx4 v68, s[28:31], s6 offen offset:1024 lds
    s_add_u32 m0, s88, 51200
    s_add_u32 s6, s69, 57344
    buffer_load_dwordx4 v68, s[28:31], s6 offen offset:0 lds
    s_add_u32 m0, s88, 51200
    s_add_u32 s6, s69, 84992
    buffer_load_dwordx4 v68, s[28:31], s6 offen offset:1024 lds
    s_mov_b32 s92, 320000
LL_27:
    ds_read_b32 v9, v164 offset:7680
    s_waitcnt lgkmcnt(0)
    v_readfirstlane_b32 s93, v9
    s_cmp_ge_u32 s93, 8
    s_cbranch_scc1 LD_28
    s_sleep 1
    s_sub_u32 s92, s92, 1
    s_cmp_lg_u32 s92, 0
    s_cbranch_scc1 LL_27
LD_28:
    s_add_u32 s7, s86, 2
    s_and_b32 s7, s7, 7
    s_mul_i32 s69, s7, 229376
    s_add_u32 s69, s69, s87
    s_add_u32 m0, s88, 81920
    s_add_u32 s6, s69, 512
    buffer_load_dwordx4 v73, s[28:31], s6 offen offset:0 lds
    s_add_u32 m0, s88, 81920
    s_add_u32 s6, s69, 28160
    buffer_load_dwordx4 v73, s[28:31], s6 offen offset:1024 lds
    s_add_u32 m0, s88, 83968
    s_add_u32 s6, s69, 57856
    buffer_load_dwordx4 v73, s[28:31], s6 offen offset:0 lds
    s_add_u32 m0, s88, 83968
    s_add_u32 s6, s69, 85504
    buffer_load_dwordx4 v73, s[28:31], s6 offen offset:1024 lds
    s_waitcnt vmcnt(4)
    s_mov_b64 exec, 1
    ds_add_u32 v164, v165 offset:7684
    s_mov_b64 exec, -1
    s_add_u32 s7, s86, 4
    s_and_b32 s7, s7, 7
    s_mul_i32 s69, s7, 229376
    s_add_u32 s69, s69, s87
    s_add_u32 m0, s88, 98304
    s_add_u32 s6, s69, 512
    buffer_load_dwordx4 v73, s[28:31], s6 offen offset:0 lds
    s_add_u32 m0, s88, 98304
    s_add_u32 s6, s69, 28160
    buffer_load_dwordx4 v73, s[28:31], s6 offen offset:1024 lds
    s_add_u32 m0, s88, 100352
    s_add_u32 s6, s69, 57856
    buffer_load_dwordx4 v73, s[28:31], s6 offen offset:0 lds
    s_add_u32 m0, s88, 100352
    s_add_u32 s6, s69, 85504
    buffer_load_dwordx4 v73, s[28:31], s6 offen offset:1024 lds
    s_setprio 2
    ds_read_b64_tr_b16 v[52:53], v69 offset:0
    ds_read_b64_tr_b16 v[54:55], v69 offset:512
    ds_read_b64_tr_b16 v[56:57], v70 offset:0
    ds_read_b64_tr_b16 v[58:59], v70 offset:512
    ds_read_b64_tr_b16 v[60:61], v69 offset:2048
    ds_read_b64_tr_b16 v[62:63], v69 offset:2560
    ds_read_b64_tr_b16 v[64:65], v70 offset:2048
    ds_read_b64_tr_b16 v[66:67], v70 offset:2560
    s_mov_b32 vcc_lo, 0
    s_mov_b32 vcc_hi, -1
    s_waitcnt lgkmcnt(6)
    v_mfma_f32_16x16x32_bf16 v[44:47], v[40:43], v[52:55], 0
    ds_read_b64_tr_b16 v[52:53], v69 offset:16384
    ds_read_b64_tr_b16 v[54:55], v69 offset:16896
    s_branch SK13
ST13:
    s_branch F_K1
SK13:
    s_waitcnt lgkmcnt(6)
    v_mfma_f32_16x16x32_bf16 v[48:51], v[40:43], v[56:59], 0
    ds_read_b64_tr_b16 v[56:57], v70 offset:16384
    ds_read_b64_tr_b16 v[58:59], v70 offset:16896
    s_waitcnt lgkmcnt(6)
    v_mfma_f32_16x16x32_bf16 v[44:47], v[40:43], v[60:63], v[44:47]
    ds_read_b64_tr_b16 v[60:61], v69 offset:18432
    ds_read_b64_tr_b16 v[62:63], v69 offset:18944
    s_waitcnt lgkmcnt(6)
    v_mfma_f32_16x16x32_bf16 v[48:51], v[40:43], v[64:67], v[48:51]
    ds_read_b64_tr_b16 v[64:65], v70 offset:18432
    ds_read_b64_tr_b16 v[66:67], v70 offset:18944
    s_waitcnt lgkmcnt(6)
    v_mfma_f32_16x16x32_bf16 v[44:47], v[40:43], v[52:55], v[44:47]
    ds_read_b64_tr_b16 v[52:53], v69 offset:32768
    ds_read_b64_tr_b16 v[54:55], v69 offset:33280
    s_waitcnt lgkmcnt(6)
    v_mfma_f32_16x16x32_bf16 v[48:51], v[40:43], v[56:59], v[48:51]
    ds_read_b64_tr_b16 v[56:57], v70 offset:32768
    ds_read_b64_tr_b16 v[58:59], v70 offset:33280
    s_waitcnt lgkmcnt(6)
    v_mfma_f32_16x16x32_bf16 v[44:47], v[40:43], v[60:63], v[44:47]
    ds_read_b64_tr_b16 v[60:61], v69 offset:34816
    ds_read_b64_tr_b16 v[62:63], v69 offset:35328
    s_waitcnt lgkmcnt(6)
    v_mfma_f32_16x16x32_bf16 v[48:51], v[40:43], v[64:67], v[48:51]
    ds_read_b64_tr_b16 v[64:65], v70 offset:34816
    ds_read_b64_tr_b16 v[66:67], v70 offset:35328
    s_waitcnt lgkmcnt(6)
    v_mfma_f32_16x16x32_bf16 v[44:47], v[40:43], v[52:55], v[44:47]
    ds_read_b64_tr_b16 v[52:53], v69 offset:49152
    ds_read_b64_tr_b16 v[54:55], v69 offset:49664
    s_waitcnt lgkmcnt(6)
    v_mfma_f32_16x16x32_bf16 v[48:51], v[40:43], v[56:59], v[48:51]
    ds_read_b64_tr_b16 v[56:57], v70 offset:49152
    ds_read_b64_tr_b16 v[58:59], v70 offset:49664
    s_waitcnt lgkmcnt(6)
    v_mfma_f32_16x16x32_bf16 v[44:47], v[40:43], v[60:63], v[44:47]
    ds_read_b64_tr_b16 v[60:61], v69 offset:51200
    ds_read_b64_tr_b16 v[62:63], v69 offset:51712
    s_waitcnt lgkmcnt(6)
    v_mfma_f32_16x16x32_bf16 v[48:51], v[40:43], v[64:67], v[48:51]
    ds_read_b64_tr_b16 v[64:65], v70 offset:51200
    ds_read_b64_tr_b16 v[66:67], v70 offset:51712
    s_waitcnt lgkmcnt(6)
    v_mfma_f32_16x16x32_bf16 v[44:47], v[40:43], v[52:55], v[44:47]
    s_waitcnt lgkmcnt(4)
    v_mfma_f32_16x16x32_bf16 v[48:51], v[40:43], v[56:59], v[48:51]
    s_waitcnt lgkmcnt(2)
    v_mfma_f32_16x16x32_bf16 v[44:47], v[40:43], v[60:63], v[44:47]
    s_waitcnt lgkmcnt(0)
    v_mfma_f32_16x16x32_bf16 v[48:51], v[40:43], v[64:67], v[48:51]
    v_add_u32 v69, 65536, v69
    v_add_u32 v70, 65536, v70
    s_nop 5
    v_cndmask_b32 v44, v44, v48, vcc
    v_cvt_pk_bf16_f32 v45, -v44, -v44
    v_and_b32 v46, s35, v45
    v_sub_f32 v46, -v44, v46
    v_cvt_pk_bf16_f32 v46, -v44, v46
    v_alignbit_b32 v47, v72, v45, 16
    ds_write_b64 v74, v[46:47] offset:16384
    s_mov_b32 s92, 320000
LL_29:
    ds_read_b32 v9, v164 offset:7700
    s_waitcnt lgkmcnt(0)
    v_readfirstlane_b32 s93, v9
    s_cmp_ge_u32 s93, 12
    s_cbranch_scc1 LD_30
    s_sleep 1
    s_sub_u32 s92, s92, 1
    s_cmp_lg_u32 s92, 0
    s_cbranch_scc1 LL_29
LD_30:
    ds_write_b64 v74, v[76:77] offset:2048
    s_add_u32 s7, s86, 0
    s_and_b32 s7, s7, 7
    s_mul_i32 s69, s7, 229376
    s_add_u32 s69, s69, s87
    s_add_u32 m0, s88, 65536
    s_add_u32 s6, s69, 512
    buffer_load_dwordx4 v73, s[28:31], s6 offen offset:0 lds
    s_add_u32 m0, s88, 65536
    s_add_u32 s6, s69, 28160
    buffer_load_dwordx4 v73, s[28:31], s6 offen offset:1024 lds
    s_add_u32 m0, s88, 67584
    s_add_u32 s6, s69, 57856
    buffer_load_dwordx4 v73, s[28:31], s6 offen offset:0 lds
    s_add_u32 m0, s88, 67584
    s_add_u32 s6, s69, 85504
    buffer_load_dwordx4 v73, s[28:31], s6 offen offset:1024 lds
    s_add_u32 s7, s86, 6
    s_and_b32 s7, s7, 7
    s_mul_i32 s69, s7, 229376
    s_add_u32 s69, s69, s87
    s_add_u32 m0, s88, 114688
    s_add_u32 s6, s69, 512
    buffer_load_dwordx4 v73, s[28:31], s6 offen offset:0 lds
    s_add_u32 m0, s88, 114688
    s_add_u32 s6, s69, 28160
    buffer_load_dwordx4 v73, s[28:31], s6 offen offset:1024 lds
    s_add_u32 m0, s88, 116736
    s_add_u32 s6, s69, 57856
    buffer_load_dwordx4 v73, s[28:31], s6 offen offset:0 lds
    s_add_u32 m0, s88, 116736
    s_add_u32 s6, s69, 85504
    buffer_load_dwordx4 v73, s[28:31], s6 offen offset:1024 lds
    buffer_load_dword v166, v78, s[24:27], 0 offen sc1
    v_mov_b32 v2, v162
    s_lshl_b32 s63, s84, 17
    s_lshr_b32 s6, s32, 3
    s_mul_i32 s6, s6, 0
    s_add_u32 s63, s63, s6
    s_lshl4_add_u32 s6, s74, s32
    s_lshl_b32 s6, s6, 11
    s_add_u32 s64, s63, s6
    v_xor_b32 v37, s32, v0
    v_and_b32 v37, 31, v37
    v_lshlrev_b32 v37, 2, v37
    s_lshr_b32 s6, s33, 1
    s_lshl2_add_u32 s6, s6, s74
    s_lshl_b32 s6, s6, 7
    s_add_u32 s68, s6, 21037056
    s_and_b32 s6, s4, 8
    s_lshl1_add_u32 s6, s6, s32
    s_lshl2_add_u32 s72, s6, s68
    s_mov_b32 s66, 0xffff
    s_mov_b32 s62, 0
    s_mov_b32 s70, 0x0000ffff
    s_mov_b32 s71, 0x0000ffff
    s_mov_b32 s59, 0
    s_mov_b32 s69, 0
    v_mov_b64 v[20:21], 0
    v_mov_b64 v[22:23], 0
    v_mov_b32 v39, 0xdddddddd
    s_nop 0
    v_mfma_f32_32x32x16_bf16 v[88:103], v[20:23], v[20:23], 0
    v_and_b32 v4, 27, v0
    v_cmp_eq_u32 vcc, 16, v4
    v_mov_b32 v4, 0x3f803f80
    v_add_u32 v3, s74, v0
    v_cndmask_b32 v4, 0, v4, vcc
    v_add_u32 v3, 1, v3
    v_mov_b32 v5, v4
    v_mfma_f32_32x32x16_bf16 v[104:119], v[20:23], v[20:23], 0
    v_and_b32 v3, 3, v3
    s_lshl_b32 s6, s82, 2
    v_add_u32 v3, s6, v3
    v_lshl_add_u32 v3, v3, 2, v164
    s_lshl_b32 s6, s58, 2
    v_add_u32 v7, s6, v164
    s_lshl1_add_u32 s6, s74, s82
    v_mfma_f32_32x32x16_bf16 v[120:135], v[20:23], v[20:23], 0
    s_lshl_b32 s6, s6, 10
    s_add_u32 s6, s6, 147456
    v_add_u32 v6, s6, v1
    v_mov_b64 v[12:13], v[4:5]
    v_mov_b64 v[14:15], v[4:5]
    v_mov_b64 v[16:17], v[4:5]
    v_mov_b64 v[18:19], v[4:5]
    v_mfma_f32_32x32x16_bf16 v[136:151], v[20:23], v[20:23], 0
    v_mov_b64 v[24:25], v[4:5]
    v_mov_b64 v[26:27], v[4:5]
    v_mov_b64 v[28:29], v[4:5]
    v_mov_b64 v[30:31], v[4:5]
    v_mov_b64 v[156:157], v[4:5]
    v_mov_b64 v[158:159], v[4:5]
    v_mov_b64 v[160:161], v[4:5]
    v_mov_b64 v[162:163], v[4:5]
    s_mov_b32 s92, 320000
LL_31:
    ds_read_b32 v9, v164 offset:7768
    s_waitcnt lgkmcnt(0)
    v_readfirstlane_b32 s93, v9
    s_cmp_ge_u32 s93, 1
    s_cbranch_scc1 LD_32
    s_sleep 1
    s_sub_u32 s92, s92, 1
    s_cmp_lg_u32 s92, 0
    s_cbranch_scc1 LL_31
LD_32:
    s_cmp_eq_u32 s89, 0
    s_waitcnt vmcnt(0)
    s_cbranch_scc1 FA_L4
    s_mov_b64 exec, 1
    ds_add_u32 v164, v165 offset:7784
    s_mov_b64 exec, -1
    s_branch SK14
ST14:
    s_branch F_K1
SK14:
    ds_read_b64_tr_b16 v[52:53], v69 offset:0
    ds_read_b64_tr_b16 v[54:55], v69 offset:512
    ds_read_b64_tr_b16 v[56:57], v70 offset:0
    ds_read_b64_tr_b16 v[58:59], v70 offset:512
    ds_read_b64_tr_b16 v[60:61], v69 offset:2048
    ds_read_b64_tr_b16 v[62:63], v69 offset:2560
    ds_read_b64_tr_b16 v[64:65], v70 offset:2048
    ds_read_b64_tr_b16 v[66:67], v70 offset:2560
    s_mov_b32 vcc_lo, 0
    s_mov_b32 vcc_hi, -1
    s_waitcnt lgkmcnt(6)
    v_mfma_f32_16x16x32_bf16 v[44:47], v[40:43], v[52:55], 0
    ds_read_b64_tr_b16 v[52:53], v69 offset:16384
    ds_read_b64_tr_b16 v[54:55], v69 offset:16896
    s_waitcnt lgkmcnt(6)
    v_mfma_f32_16x16x32_bf16 v[48:51], v[40:43], v[56:59], 0
    ds_read_b64_tr_b16 v[56:57], v70 offset:16384
    ds_read_b64_tr_b16 v[58:59], v70 offset:16896
    s_waitcnt lgkmcnt(6)
    v_mfma_f32_16x16x32_bf16 v[44:47], v[40:43], v[60:63], v[44:47]
    ds_read_b64_tr_b16 v[60:61], v69 offset:18432
    ds_read_b64_tr_b16 v[62:63], v69 offset:18944
    s_waitcnt lgkmcnt(6)
    v_mfma_f32_16x16x32_bf16 v[48:51], v[40:43], v[64:67], v[48:51]
    ds_read_b64_tr_b16 v[64:65], v70 offset:18432
    ds_read_b64_tr_b16 v[66:67], v70 offset:18944
    s_waitcnt lgkmcnt(6)
    v_mfma_f32_16x16x32_bf16 v[44:47], v[40:43], v[52:55], v[44:47]
    ds_read_b64_tr_b16 v[52:53], v69 offset:32768
    ds_read_b64_tr_b16 v[54:55], v69 offset:33280
    s_waitcnt lgkmcnt(6)
    v_mfma_f32_16x16x32_bf16 v[48:51], v[40:43], v[56:59], v[48:51]
    ds_read_b64_tr_b16 v[56:57], v70 offset:32768
    ds_read_b64_tr_b16 v[58:59], v70 offset:33280
    s_waitcnt lgkmcnt(6)
    v_mfma_f32_16x16x32_bf16 v[44:47], v[40:43], v[60:63], v[44:47]
    ds_read_b64_tr_b16 v[60:61], v69 offset:34816
    ds_read_b64_tr_b16 v[62:63], v69 offset:35328
    s_waitcnt lgkmcnt(6)
    v_mfma_f32_16x16x32_bf16 v[48:51], v[40:43], v[64:67], v[48:51]
    ds_read_b64_tr_b16 v[64:65], v70 offset:34816
    ds_read_b64_tr_b16 v[66:67], v70 offset:35328
    s_waitcnt lgkmcnt(6)
    v_mfma_f32_16x16x32_bf16 v[44:47], v[40:43], v[52:55], v[44:47]
    ds_read_b64_tr_b16 v[52:53], v69 offset:49152
    ds_read_b64_tr_b16 v[54:55], v69 offset:49664
    buffer_load_dword v5, v37, s[16:19], s68 offen nt
    s_waitcnt lgkmcnt(6)
    v_mfma_f32_16x16x32_bf16 v[48:51], v[40:43], v[56:59], v[48:51]
    ds_read_b64_tr_b16 v[56:57], v70 offset:49152
    ds_read_b64_tr_b16 v[58:59], v70 offset:49664
    s_waitcnt lgkmcnt(6)
    v_mfma_f32_16x16x32_bf16 v[44:47], v[40:43], v[60:63], v[44:47]
    ds_read_b64_tr_b16 v[60:61], v69 offset:51200
    ds_read_b64_tr_b16 v[62:63], v69 offset:51712
    s_waitcnt lgkmcnt(6)
    v_mfma_f32_16x16x32_bf16 v[48:51], v[40:43], v[64:67], v[48:51]
    ds_read_b64_tr_b16 v[64:65], v70 offset:51200
    ds_read_b64_tr_b16 v[66:67], v70 offset:51712
    s_waitcnt lgkmcnt(6)
    v_mfma_f32_16x16x32_bf16 v[44:47], v[40:43], v[52:55], v[44:47]
    s_waitcnt lgkmcnt(4)
    v_mfma_f32_16x16x32_bf16 v[48:51], v[40:43], v[56:59], v[48:51]
    s_waitcnt lgkmcnt(2)
    v_mfma_f32_16x16x32_bf16 v[44:47], v[40:43], v[60:63], v[44:47]
    s_waitcnt lgkmcnt(0)
    v_mfma_f32_16x16x32_bf16 v[48:51], v[40:43], v[64:67], v[48:51]
    s_nop 7
    v_cndmask_b32 v44, v44, v48, vcc
    v_cvt_pk_bf16_f32 v45, -v44, -v44
    v_and_b32 v46, s35, v45
    v_sub_f32 v46, -v44, v46
    v_cvt_pk_bf16_f32 v46, -v44, v46
    v_alignbit_b32 v47, v71, v45, 16
    ds_write_b64 v74, v[46:47] offset:2048
    s_branch FA_L3
FA_L4:
    buffer_load_dword v5, v37, s[16:19], s68 offen nt
FA_L3:
    s_cmp_lg_u32 s58, 7
    s_cbranch_scc1 FA_EJ
    s_mov_b32 s92, 40000
    s_branch PC_35
PL_33:
    buffer_load_dword v166, v78, s[24:27], 0 offen sc1
    s_waitcnt vmcnt(0)
PC_35:
    v_and_b32 v9, 32, v166
    v_cmp_ne_u32 s[94:95], 0, v9
    s_cmp_eq_u64 s[94:95], -1
    s_cbranch_scc1 PD_34
    s_sleep 4
    s_sub_u32 s92, s92, 1
    s_cmp_lg_u32 s92, 0
    s_cbranch_scc1 PL_33
PD_34:
    s_mov_b64 exec, 1
    ds_add_u32 v164, v165 offset:7708
    s_mov_b64 exec, -1
    s_branch FA_EJ
F_G2:
    s_mov_b32 s16, s56
    s_mov_b32 s17, s57
    s_mov_b32 s18, 268435456
    s_mov_b32 s19, 0x00020000
    s_mov_b32 s24, s54
    s_mov_b32 s25, s55
    s_mov_b32 s26, 256
    s_mov_b32 s27, 0x00020000
    v_mov_b32 v18, -1
    v_mov_b32 v19, -1
    v_mov_b32 v20, -1
    v_mov_b32 v21, -1
    s_lshl4_add_u32 s88, s33, s32
    s_lshl_b32 s88, s88, 7
    s_add_u32 s88, s88, 20971536
    s_lshr_b32 s6, s33, 1
    s_lshl_b32 s6, s6, 5
    s_cmp_eq_u32 s3, 0
    s_cselect_b32 s7, s88, 268435456
    s_cselect_b32 s6, s6, 256
    v_lshlrev_b32 v9, 2, v0
    v_add_u32 v30, s7, v9
    v_mov_b32 v31, s6
    s_lshr_b32 s6, s33, 1
    s_lshl2_add_u32 s6, s6, s5
    s_lshl_b32 s6, s6, 7
    s_add_u32 s6, s6, 21036928
    s_lshl4_add_u32 s7, s3, s5
    s_cmp_lt_u32 s7, 4
    s_cselect_b32 s6, s6, 268435456
    s_mov_b32 exec_lo, 0
    v_add_u32 v30, s6, v9
    s_mov_b32 exec_lo, -1
    v_mov_b32 v32, 0
    s_lshl2_add_u32 s88, s3, s88
    s_getreg_b32 s6, hwreg(HW_REG_XCC_ID, 0, 4)
    s_mul_i32 s7, s6, s6
    s_lshl_b32 s7, s7, 9
    s_add_u32 s7, s7, s6
    s_lshl_b32 s7, s7, 6
    s_add_u32 s7, s7, 1
    v_mov_b32 v35, s7
    s_lshl_b32 s91, s7, 5
    s_mov_b32 s35, 0xffff0000
    s_add_u32 s6, s65, 131072
    v_add_u32 v17, s6, v1
    s_lshl_b32 s63, s3, 14
    s_add_u32 s66, s34, 1
    s_and_b32 s66, s66, 7
    s_mul_i32 s66, s66, 196608
    s_add_u32 m0, s64, 81920
    s_add_u32 s67, s66, s61
    buffer_load_dwordx4 v14, s[12:15], s67 offen offset:0 lds
    buffer_load_dwordx4 v15, s[12:15], s67 offen offset:1024 lds
    s_add_u32 m0, s65, 90112
    s_add_u32 s67, s66, s62
    buffer_load_dwordx4 v16, s[12:15], s67 offen lds
    s_lshl_b32 s7, s3, 12
    v_and_b32 v6, 31, v0
    v_lshrrev_b32 v7, 5, v0
    v_bfe_u32 v10, v0, 1, 3
    v_xor_b32 v7, v7, v10
    v_lshlrev_b32 v10, 7, v6
    v_lshl_add_u32 v10, v7, 4, v10
    v_add_u32 v10, s7, v10
    v_xor_b32 v11, 32, v10
    v_xor_b32 v12, 64, v10
    v_xor_b32 v13, 96, v10
    v_lshrrev_b32 v6, 5, v0
    v_bfe_u32 v7, v0, 2, 2
    v_lshl_add_u32 v6, v6, 3, v7
    v_lshlrev_b32 v37, 7, v6
    v_bfe_u32 v6, v0, 3, 1
    v_lshl_add_u32 v37, v6, 6, v37
    v_and_b32 v6, 16, v0
    v_lshl_add_u32 v37, v6, 1, v37
    v_and_b32 v6, 3, v0
    v_lshl_add_u32 v37, v6, 3, v37
    v_add_u32 v37, 0, v37
    s_lshr_b32 s6, s33, 2
    s_mul_i32 s6, s6, 896
    s_and_b32 s7, s33, 3
    s_lshl_b32 s68, s7, 7
    s_add_u32 s68, s68, s6
    s_lshl_b32 s68, s68, 5
    s_lshl2_add_u32 s6, s32, s3
    s_mul_i32 s60, s6, 114688
    s_add_u32 s60, s60, 4194304
    s_add_u32 s60, s60, s68
    s_lshr_b32 s90, s65, 1
    s_branch SK15
ST15:
    s_branch F_K1
SK15:
    s_add_u32 s90, s90, 157696
    s_mov_b32 s79, 0x05040100
    v_lshrrev_b32 v6, 2, v1
    v_and_b32 v6, 64, v6
    v_xor_b32 v6, v6, v1
    v_and_b32 v6, 0x70, v6
    v_lshrrev_b32 v166, 7, v1
    v_lshl_add_u32 v166, v166, 10, v6
    v_add_u32 v36, 155648, v9
    ds_write_b32 v36, v32 offset:7680
    ds_write_b128 v17, v[18:21] offset:26624
    v_mov_b32 v22, 155648
    v_mov_b32 v23, 1
    v_mov_b32 v24, 0x100
    s_waitcnt vmcnt(3) lgkmcnt(0)
    s_barrier
    s_setprio 3
    s_add_u32 s66, s34, 2
    s_and_b32 s66, s66, 7
    s_mul_i32 s66, s66, 196608
    s_add_u32 m0, s64, 98304
    s_add_u32 s67, s66, s61
    buffer_load_dwordx4 v14, s[12:15], s67 offen offset:0 lds
    buffer_load_dwordx4 v15, s[12:15], s67 offen offset:1024 lds
    s_add_u32 m0, s65, 106496
    s_add_u32 s67, s66, s62
    buffer_load_dwordx4 v16, s[12:15], s67 offen lds
    v_lshlrev_b32 v33, 21, v0
    s_mov_b64 exec, 0x403
    buffer_load_dword v33, v33, s[16:19], 0 offen
    buffer_load_dword v34, off, s[24:27], 0
    s_mov_b64 exec, -1
    ds_read_b128 v[38:41], v10 offset:0
    ds_read_b128 v[42:45], v11 offset:0
    ds_read_b128 v[46:49], v12 offset:0
    ds_read_b128 v[50:53], v13 offset:0
    s_waitcnt vmcnt(5) lgkmcnt(0)
    s_barrier
    s_add_u32 s66, s34, 3
    s_and_b32 s66, s66, 7
    s_mul_i32 s66, s66, 196608
    s_add_u32 m0, s64, 114688
    s_add_u32 s67, s66, s61
    buffer_load_dwordx4 v14, s[12:15], s67 offen offset:0 lds
    buffer_load_dwordx4 v15, s[12:15], s67 offen offset:1024 lds
    s_add_u32 m0, s65, 122880
    s_add_u32 s67, s66, s62
    buffer_load_dwordx4 v16, s[12:15], s67 offen lds
    s_mov_b32 exec_lo, 15
    buffer_store_dword v32, v30, s[16:19], 0 offen sc1
    s_mov_b32 exec_lo, -1
    ds_read_b128 v[54:57], v10 offset:16384
    ds_read_b128 v[58:61], v11 offset:16384
    ds_read_b128 v[62:65], v12 offset:16384
    ds_read_b128 v[66:69], v13 offset:16384
    s_waitcnt vmcnt(6) lgkmcnt(0)
    s_barrier
    s_add_u32 s66, s34, 4
    s_and_b32 s66, s66, 7
    s_mul_i32 s66, s66, 196608
    s_add_u32 m0, s64, 0
    s_add_u32 s67, s66, s61
    buffer_load_dwordx4 v14, s[12:15], s67 offen offset:0 lds
    buffer_load_dwordx4 v15, s[12:15], s67 offen offset:1024 lds
    s_add_u32 m0, s65, 8192
    s_add_u32 s67, s66, s62
    buffer_load_dwordx4 v16, s[12:15], s67 offen lds
    ds_read_b128 v[70:73], v10 offset:32768
    ds_read_b128 v[74:77], v11 offset:32768
    ds_read_b128 v[78:81], v12 offset:32768
    ds_read_b128 v[82:85], v13 offset:32768
    s_waitcnt vmcnt(3) lgkmcnt(0)
    s_barrier
    s_add_u32 s66, s34, 5
    s_and_b32 s66, s66, 7
    s_mul_i32 s66, s66, 196608
    s_add_u32 m0, s64, 131072
    s_add_u32 s67, s66, s61
    buffer_load_dwordx4 v14, s[12:15], s67 offen offset:0 lds
    buffer_load_dwordx4 v15, s[12:15], s67 offen offset:1024 lds
    s_add_u32 m0, s65, 139264
    s_add_u32 s67, s66, s62
    buffer_load_dwordx4 v16, s[12:15], s67 offen lds
    ds_read_b128 v[86:89], v10 offset:49152
    ds_read_b128 v[90:93], v11 offset:49152
    ds_read_b128 v[94:97], v12 offset:49152
    ds_read_b128 v[98:101], v13 offset:49152
    s_waitcnt vmcnt(3) lgkmcnt(0)
    s_barrier
    s_add_u32 s66, s34, 6
    s_and_b32 s66, s66, 7
    s_mul_i32 s66, s66, 196608
    s_add_u32 m0, s64, 143360
    s_add_u32 s67, s66, s61
    buffer_load_dwordx4 v14, s[12:15], s67 offen offset:0 lds
    buffer_load_dwordx4 v15, s[12:15], s67 offen offset:1024 lds
    s_add_u32 m0, s65, 151552
    s_add_u32 s67, s66, s62
    buffer_load_dwordx4 v16, s[12:15], s67 offen lds
    v_add_u32 v10, 65536, v10
    v_add_u32 v11, 65536, v11
    v_add_u32 v12, 65536, v12
    v_add_u32 v13, 65536, v13
    ds_read_b128 v[102:105], v10 offset:0
    ds_read_b128 v[106:109], v11 offset:0
    ds_read_b128 v[110:113], v12 offset:0
    ds_read_b128 v[114:117], v13 offset:0
    s_waitcnt vmcnt(3) lgkmcnt(0)
    s_barrier
    s_add_u32 s66, s34, 7
    s_and_b32 s66, s66, 7
    s_mul_i32 s66, s66, 196608
    s_add_u32 m0, s64, 65536
    s_add_u32 s67, s66, s61
    buffer_load_dwordx4 v14, s[12:15], s67 offen offset:0 lds
    buffer_load_dwordx4 v15, s[12:15], s67 offen offset:1024 lds
    s_add_u32 m0, s65, 73728
    s_add_u32 s67, s66, s62
    buffer_load_dwordx4 v16, s[12:15], s67 offen lds
    ds_read_b128 v[118:121], v10 offset:16384
    ds_read_b128 v[122:125], v11 offset:16384
    ds_read_b128 v[126:129], v12 offset:16384
    s_branch SK16
.p2align 12
ST16:
    s_branch F_K1
SK16:
    ds_read_b128 v[130:133], v13 offset:16384
    s_waitcnt vmcnt(3)
    s_mov_b64 exec, 1
    ds_add_u32 v22, v23 offset:7800
    s_mov_b64 exec, -1
    s_mov_b32 s92, 320000
LL_36:
    ds_read_b32 v6, v22 offset:7800
    s_waitcnt lgkmcnt(0)
    v_readfirstlane_b32 s93, v6
    s_bitcmp1_b32 s93, 3
    s_cbranch_scc1 LD_37
    s_sleep 1
    s_sub_u32 s92, s92, 1
    s_cmp_lg_u32 s92, 0
    s_cbranch_scc1 LL_36
LD_37:
    ds_read_b128 v[134:137], v10 offset:32768
    ds_read_b128 v[138:141], v11 offset:32768
    ds_read_b128 v[142:145], v12 offset:32768
    ds_read_b128 v[146:149], v13 offset:32768
    s_waitcnt vmcnt(0)
    s_mov_b64 exec, 1
    ds_add_u32 v22, v24 offset:7800
    s_mov_b64 exec, -1
    s_mov_b32 s92, 320000
LL_38:
    ds_read_b32 v6, v22 offset:7800
    s_waitcnt lgkmcnt(0)
    v_readfirstlane_b32 s93, v6
    s_bitcmp1_b32 s93, 11
    s_cbranch_scc1 LD_39
    s_sleep 1
    s_sub_u32 s92, s92, 1
    s_cmp_lg_u32 s92, 0
    s_cbranch_scc1 LL_38
LD_39:
    buffer_load_dword v25, v31, s[24:27], 0 offen sc1
    ds_read_b128 v[150:153], v10 offset:49152
    ds_read_b128 v[154:157], v11 offset:49152
    ds_read_b128 v[158:161], v12 offset:49152
    ds_read_b128 v[162:165], v13 offset:49152
    s_waitcnt lgkmcnt(0)
    s_mov_b64 exec, 1
    ds_add_u32 v22, v23 offset:7700
    s_mov_b64 exec, -1
    s_lshl2_add_u32 s6, s32, s3
    s_lshl_b32 s6, s6, 15
    s_lshl_b32 s7, s33, 11
    s_add_u32 s6, s6, s7
    s_add_u32 s84, s6, 16777216
    buffer_store_dwordx4 v[18:21], v1, s[16:19], s84 offen offset:0 sc1
    buffer_store_dwordx4 v[18:21], v1, s[16:19], s84 offen offset:1024 sc1
    s_cmp_lg_u32 s3, 0
    s_waitcnt vmcnt(2)
    s_cbranch_scc1 F_H2
    s_mov_b32 s92, 40000
F_H0:
    v_readfirstlane_b32 s6, v25
    s_bitcmp1_b32 s6, 5
    s_cbranch_scc1 F_H1
    buffer_load_dword v25, v31, s[24:27], 0 offen sc1
    s_sub_u32 s92, s92, 1
    s_cmp_lg_u32 s92, 0
    s_waitcnt vmcnt(0)
    s_cbranch_scc1 F_H0
F_H1:
    s_cmp_lg_u32 s6, s91
    s_cbranch_scc1 F_NL
    s_mov_b64 exec, 1
    ds_add_u32 v22, v23 offset:7772
    s_mov_b64 exec, -1
    v_lshlrev_b32 v25, 7, v0
    s_lshr_b32 s6, s33, 1
    s_lshl_b32 s6, s6, 9
    s_add_u32 s6, s6, 21037056
    s_mov_b32 m0, 162304
    s_mov_b64 exec, 15
    buffer_load_dword v25, s[16:19], s6 offen nt lds
    s_mov_b64 exec, -1
F_NL:
    s_mov_b64 exec, 1
    ds_add_u32 v22, v23 offset:7768
    s_mov_b64 exec, -1
F_H2:
    v_mov_b32 v0, v37
    s_and_b32 s76, s33, 3
    s_lshr_b32 s6, s33, 2
    s_lshl4_add_u32 s6, s6, s32
    s_lshl2_add_u32 s6, s6, s3
    s_lshl_b32 s6, s6, 10
    s_add_u32 s58, s6, 21233664
    s_mov_b32 s6, s32
    s_mov_b32 s32, s33
    s_mov_b32 s33, s6
    s_mul_i32 s72, s32, 458752
    s_add_u32 s72, s72, 4194304
    s_and_b32 s6, s33, 1
    s_lshl_b32 s6, s6, 1
    s_and_b32 s7, s3, 1
    s_add_u32 s73, s6, s7
    s_lshl_b32 s75, s6, 2
    s_mul_i32 s6, s3, 28672
    s_add_u32 s72, s72, s6
    s_mul_i32 s7, s73, 114688
    s_add_u32 s64, s72, s7
    s_xor_b32 s7, s73, 1
    s_mul_i32 s7, s7, 114688
    s_add_u32 s65, s72, s7
    s_lshl_b32 s6, s32, 7
    s_lshl_b32 s7, s3, 13
    s_add_u32 s75, s75, s6
    s_add_u32 s75, s75, s7
    s_add_u32 s75, s75, 20971536
    s_lshr_b32 s77, s33, 1
    s_add_u32 s80, s77, s32
    s_and_b32 s80, s80, 3
    s_lshl_b32 s77, s77, 7
    s_mul_i32 s66, s3, 458752
    s_add_u32 s66, s66, s77
    s_lshr_b32 s6, s3, 1
    s_lshl_b32 s74, s6, 6
    s_add_u32 s78, s77, s74
    s_lshl4_add_u32 s6, s3, s32
    s_lshl2_add_u32 s6, s6, s73
    s_lshl_b32 s6, s6, 10
    s_add_u32 s59, s6, 21233664
    s_mov_b32 s12, s48
    s_mov_b32 s13, s49
    s_mov_b32 s14, 1835008
    s_mov_b32 s15, 0x00020000
    s_mov_b32 s24, s50
    s_mov_b32 s25, s51
    s_mov_b32 s26, 1024
    s_mov_b32 s27, 0x00020000
    s_mov_b32 s92, 320000
LL_40:
    ds_read_b32 v6, v22 offset:7684
    s_waitcnt lgkmcnt(0)
    v_readfirstlane_b32 s93, v6
    s_cmp_ge_u32 s93, 4
    s_cbranch_scc1 LD_41
    s_sleep 1
    s_sub_u32 s92, s92, 1
    s_cmp_lg_u32 s92, 0
    s_cbranch_scc1 LL_40
LD_41:
    s_setprio 0
    ds_read_b64_tr_b16 v[2:3], v0 offset:0
    ds_read_b64_tr_b16 v[4:5], v0 offset:512
    ds_read_b64_tr_b16 v[6:7], v0 offset:2048
    ds_read_b64_tr_b16 v[8:9], v0 offset:2560
    ds_read_b64_tr_b16 v[10:11], v0 offset:4096
    ds_read_b64_tr_b16 v[12:13], v0 offset:4608
    ds_read_b64_tr_b16 v[14:15], v0 offset:6144
    ds_read_b64_tr_b16 v[16:17], v0 offset:6656
    ds_read_b64_tr_b16 v[18:19], v0 offset:8192
    ds_read_b64_tr_b16 v[20:21], v0 offset:8704
    s_waitcnt lgkmcnt(8)
    v_mfma_f32_32x32x16_bf16 v[22:37], v[2:5], v[38:41], 0
    ds_read_b64_tr_b16 v[2:3], v0 offset:10240
    ds_read_b64_tr_b16 v[4:5], v0 offset:10752
    s_waitcnt lgkmcnt(8)
    v_mfma_f32_32x32x16_bf16 v[22:37], v[6:9], v[42:45], v[22:37]
    ds_read_b64_tr_b16 v[6:7], v0 offset:12288
    ds_read_b64_tr_b16 v[8:9], v0 offset:12800
    s_waitcnt lgkmcnt(8)
    v_mfma_f32_32x32x16_bf16 v[22:37], v[10:13], v[46:49], v[22:37]
    ds_read_b64_tr_b16 v[10:11], v0 offset:14336
    ds_read_b64_tr_b16 v[12:13], v0 offset:14848
    s_waitcnt lgkmcnt(8)
    v_mfma_f32_32x32x16_bf16 v[22:37], v[14:17], v[50:53], v[22:37]
    ds_read_b64_tr_b16 v[14:15], v0 offset:16384
    ds_read_b64_tr_b16 v[16:17], v0 offset:16896
    s_waitcnt lgkmcnt(8)
    v_mfma_f32_32x32x16_bf16 v[22:37], v[18:21], v[54:57], v[22:37]
    ds_read_b64_tr_b16 v[18:19], v0 offset:18432
    ds_read_b64_tr_b16 v[20:21], v0 offset:18944
    s_waitcnt lgkmcnt(8)
    v_mfma_f32_32x32x16_bf16 v[22:37], v[2:5], v[58:61], v[22:37]
    ds_read_b64_tr_b16 v[2:3], v0 offset:20480
    ds_read_b64_tr_b16 v[4:5], v0 offset:20992
    s_waitcnt lgkmcnt(8)
    v_mfma_f32_32x32x16_bf16 v[22:37], v[6:9], v[62:65], v[22:37]
    ds_read_b64_tr_b16 v[6:7], v0 offset:22528
    ds_read_b64_tr_b16 v[8:9], v0 offset:23040
    s_waitcnt lgkmcnt(8)
    v_mfma_f32_32x32x16_bf16 v[22:37], v[10:13], v[66:69], v[22:37]
    ds_read_b64_tr_b16 v[10:11], v0 offset:24576
    ds_read_b64_tr_b16 v[12:13], v0 offset:25088
    s_waitcnt lgkmcnt(8)
    v_mfma_f32_32x32x16_bf16 v[22:37], v[14:17], v[70:73], v[22:37]
    ds_read_b64_tr_b16 v[14:15], v0 offset:26624
    ds_read_b64_tr_b16 v[16:17], v0 offset:27136
    s_waitcnt lgkmcnt(8)
    v_mfma_f32_32x32x16_bf16 v[22:37], v[18:21], v[74:77], v[22:37]
    ds_read_b64_tr_b16 v[18:19], v0 offset:28672
    ds_read_b64_tr_b16 v[20:21], v0 offset:29184
    s_waitcnt lgkmcnt(8)
    v_mfma_f32_32x32x16_bf16 v[22:37], v[2:5], v[78:81], v[22:37]
    s_branch SK17
ST17:
    s_branch F_K1
SK17:
    ds_read_b64_tr_b16 v[2:3], v0 offset:30720
    ds_read_b64_tr_b16 v[4:5], v0 offset:31232
    s_waitcnt lgkmcnt(8)
    v_mfma_f32_32x32x16_bf16 v[22:37], v[6:9], v[82:85], v[22:37]
    ds_read_b64_tr_b16 v[6:7], v0 offset:32768
    ds_read_b64_tr_b16 v[8:9], v0 offset:33280
    s_waitcnt lgkmcnt(8)
    v_mfma_f32_32x32x16_bf16 v[22:37], v[10:13], v[86:89], v[22:37]
    ds_read_b64_tr_b16 v[10:11], v0 offset:34816
    ds_read_b64_tr_b16 v[12:13], v0 offset:35328
    s_waitcnt lgkmcnt(8)
    v_mfma_f32_32x32x16_bf16 v[22:37], v[14:17], v[90:93], v[22:37]
    ds_read_b64_tr_b16 v[14:15], v0 offset:36864
    ds_read_b64_tr_b16 v[16:17], v0 offset:37376
    s_waitcnt lgkmcnt(8)
    v_mfma_f32_32x32x16_bf16 v[22:37], v[18:21], v[94:97], v[22:37]
    ds_read_b64_tr_b16 v[18:19], v0 offset:38912
    ds_read_b64_tr_b16 v[20:21], v0 offset:39424
    s_waitcnt lgkmcnt(8)
    v_mfma_f32_32x32x16_bf16 v[22:37], v[2:5], v[98:101], v[22:37]
    ds_read_b64_tr_b16 v[2:3], v0 offset:40960
    ds_read_b64_tr_b16 v[4:5], v0 offset:41472
    s_waitcnt lgkmcnt(8)
    v_mfma_f32_32x32x16_bf16 v[22:37], v[6:9], v[102:105], v[22:37]
    ds_read_b64_tr_b16 v[6:7], v0 offset:43008
    ds_read_b64_tr_b16 v[8:9], v0 offset:43520
    s_waitcnt lgkmcnt(8)
    v_mfma_f32_32x32x16_bf16 v[22:37], v[10:13], v[106:109], v[22:37]
    ds_read_b64_tr_b16 v[10:11], v0 offset:45056
    ds_read_b64_tr_b16 v[12:13], v0 offset:45568
    s_waitcnt lgkmcnt(8)
    v_mfma_f32_32x32x16_bf16 v[22:37], v[14:17], v[110:113], v[22:37]
    ds_read_b64_tr_b16 v[14:15], v0 offset:47104
    ds_read_b64_tr_b16 v[16:17], v0 offset:47616
    s_waitcnt lgkmcnt(8)
    v_mfma_f32_32x32x16_bf16 v[22:37], v[18:21], v[114:117], v[22:37]
    ds_read_b64_tr_b16 v[18:19], v0 offset:49152
    ds_read_b64_tr_b16 v[20:21], v0 offset:49664
    s_waitcnt lgkmcnt(8)
    v_mfma_f32_32x32x16_bf16 v[22:37], v[2:5], v[118:121], v[22:37]
    ds_read_b64_tr_b16 v[2:3], v0 offset:51200
    ds_read_b64_tr_b16 v[4:5], v0 offset:51712
    s_waitcnt lgkmcnt(8)
    v_mfma_f32_32x32x16_bf16 v[22:37], v[6:9], v[122:125], v[22:37]
    ds_read_b64_tr_b16 v[6:7], v0 offset:53248
    ds_read_b64_tr_b16 v[8:9], v0 offset:53760
    s_waitcnt lgkmcnt(8)
    v_mfma_f32_32x32x16_bf16 v[22:37], v[10:13], v[126:129], v[22:37]
    ds_read_b64_tr_b16 v[10:11], v0 offset:55296
    ds_read_b64_tr_b16 v[12:13], v0 offset:55808
    s_waitcnt lgkmcnt(8)
    v_mfma_f32_32x32x16_bf16 v[22:37], v[14:17], v[130:133], v[22:37]
    ds_read_b64_tr_b16 v[14:15], v0 offset:57344
    ds_read_b64_tr_b16 v[16:17], v0 offset:57856
    s_waitcnt lgkmcnt(8)
    v_mfma_f32_32x32x16_bf16 v[22:37], v[18:21], v[134:137], v[22:37]
    ds_read_b64_tr_b16 v[18:19], v0 offset:59392
    ds_read_b64_tr_b16 v[20:21], v0 offset:59904
    s_waitcnt lgkmcnt(8)
    v_mfma_f32_32x32x16_bf16 v[22:37], v[2:5], v[138:141], v[22:37]
    ds_read_b64_tr_b16 v[2:3], v0 offset:61440
    ds_read_b64_tr_b16 v[4:5], v0 offset:61952
    s_waitcnt lgkmcnt(8)
    v_mfma_f32_32x32x16_bf16 v[22:37], v[6:9], v[142:145], v[22:37]
    ds_read_b64_tr_b16 v[6:7], v0 offset:63488
    ds_read_b64_tr_b16 v[8:9], v0 offset:64000
    s_waitcnt lgkmcnt(8)
    v_mfma_f32_32x32x16_bf16 v[22:37], v[10:13], v[146:149], v[22:37]
    s_setprio 3
    v_add_u32 v10, 143360, v1
    s_setprio 0
    ds_read_b128 v[10:13], v10 offset:16384
    s_waitcnt lgkmcnt(7)
    v_mfma_f32_32x32x16_bf16 v[22:37], v[14:17], v[150:153], v[22:37]
    s_setprio 3
    v_and_b32 v14, 0x1ff, v1
    v_add_u32 v14, s90, v14
    s_setprio 0
    ds_read_b128 v[14:17], v14
    s_waitcnt lgkmcnt(6)
    v_mfma_f32_32x32x16_bf16 v[22:37], v[18:21], v[154:157], v[22:37]
    s_waitcnt lgkmcnt(4)
    v_mfma_f32_32x32x16_bf16 v[22:37], v[2:5], v[158:161], v[22:37]
    s_waitcnt lgkmcnt(2)
    v_mfma_f32_32x32x16_bf16 v[22:37], v[6:9], v[162:165], v[22:37]
    s_setprio 3
    s_waitcnt lgkmcnt(0)
    v_max3_u32 v21, v10, v12, v16
    v_cmp_eq_u32 vcc, -1, v21
    s_cbranch_vccnz F_CW0
F_CR0:
    s_cmp_lg_u32 s76, 0
    s_cbranch_scc1 F_RS
    buffer_store_dword v17, v1, s[16:19], s58 offen sc1
F_RS:
    v_perm_b32 v17, v16, v15, s79
    v_mov_b32 v16, v14
    v_xor_b32 v0, 64, v0
    s_nop 0
    v_mfma_f32_32x32x16_bf16 v[22:37], v[10:13], v[14:17], v[22:37]
    ds_read_b64_tr_b16 v[2:3], v0 offset:0
    ds_read_b64_tr_b16 v[4:5], v0 offset:512
    ds_read_b64_tr_b16 v[6:7], v0 offset:2048
    ds_read_b64_tr_b16 v[8:9], v0 offset:2560
    ds_read_b64_tr_b16 v[10:11], v0 offset:4096
    ds_read_b64_tr_b16 v[12:13], v0 offset:4608
    ds_read_b64_tr_b16 v[14:15], v0 offset:6144
    ds_read_b64_tr_b16 v[16:17], v0 offset:6656
    ds_read_b64_tr_b16 v[18:19], v0 offset:8192
    ds_read_b64_tr_b16 v[20:21], v0 offset:8704
    s_add_u32 s6, s60, 0
    s_nop 0
    v_mul_f32 v22, v22, |v22|
    v_mul_f32 v23, v23, |v23|
    v_cvt_pk_bf16_f32 v22, v22, v23
    v_pk_max_i16 v22, v22, 0
    v_mul_f32 v24, v24, |v24|
    v_mul_f32 v25, v25, |v25|
    v_cvt_pk_bf16_f32 v23, v24, v25
    v_pk_max_i16 v23, v23, 0
    v_mul_f32 v26, v26, |v26|
    v_mul_f32 v27, v27, |v27|
    v_cvt_pk_bf16_f32 v24, v26, v27
    v_pk_max_i16 v24, v24, 0
    v_mul_f32 v28, v28, |v28|
    v_mul_f32 v29, v29, |v29|
    v_cvt_pk_bf16_f32 v25, v28, v29
    v_pk_max_i16 v25, v25, 0
    buffer_store_dwordx4 v[22:25], v1, s[16:19], s6 offen offset:0 sc1
    v_mul_f32 v30, v30, |v30|
    v_mul_f32 v31, v31, |v31|
    v_cvt_pk_bf16_f32 v30, v30, v31
    v_pk_max_i16 v30, v30, 0
    v_mul_f32 v32, v32, |v32|
    v_mul_f32 v33, v33, |v33|
    v_cvt_pk_bf16_f32 v31, v32, v33
    v_pk_max_i16 v31, v31, 0
    v_mul_f32 v34, v34, |v34|
    v_mul_f32 v35, v35, |v35|
    v_cvt_pk_bf16_f32 v32, v34, v35
    v_pk_max_i16 v32, v32, 0
    v_mul_f32 v36, v36, |v36|
    v_mul_f32 v37, v37, |v37|
    v_cvt_pk_bf16_f32 v33, v36, v37
    v_pk_max_i16 v33, v33, 0
    buffer_store_dwordx4 v[30:33], v1, s[16:19], s6 offen offset:1024 sc1
    s_setprio 0
    s_waitcnt lgkmcnt(8)
    v_mfma_f32_32x32x16_bf16 v[22:37], v[2:5], v[38:41], 0
    ds_read_b64_tr_b16 v[2:3], v0 offset:10240
    ds_read_b64_tr_b16 v[4:5], v0 offset:10752
    s_waitcnt lgkmcnt(8)
    v_mfma_f32_32x32x16_bf16 v[22:37], v[6:9], v[42:45], v[22:37]
    ds_read_b64_tr_b16 v[6:7], v0 offset:12288
    ds_read_b64_tr_b16 v[8:9], v0 offset:12800
    s_waitcnt lgkmcnt(8)
    v_mfma_f32_32x32x16_bf16 v[22:37], v[10:13], v[46:49], v[22:37]
    ds_read_b64_tr_b16 v[10:11], v0 offset:14336
    ds_read_b64_tr_b16 v[12:13], v0 offset:14848
    s_branch SK18
ST18:
    s_branch F_K1
SK18:
    s_waitcnt lgkmcnt(8)
    v_mfma_f32_32x32x16_bf16 v[22:37], v[14:17], v[50:53], v[22:37]
    ds_read_b64_tr_b16 v[14:15], v0 offset:16384
    ds_read_b64_tr_b16 v[16:17], v0 offset:16896
    s_waitcnt lgkmcnt(8)
    v_mfma_f32_32x32x16_bf16 v[22:37], v[18:21], v[54:57], v[22:37]
    ds_read_b64_tr_b16 v[18:19], v0 offset:18432
    ds_read_b64_tr_b16 v[20:21], v0 offset:18944
    s_waitcnt lgkmcnt(8)
    v_mfma_f32_32x32x16_bf16 v[22:37], v[2:5], v[58:61], v[22:37]
    ds_read_b64_tr_b16 v[2:3], v0 offset:20480
    ds_read_b64_tr_b16 v[4:5], v0 offset:20992
    s_waitcnt lgkmcnt(8)
    v_mfma_f32_32x32x16_bf16 v[22:37], v[6:9], v[62:65], v[22:37]
    ds_read_b64_tr_b16 v[6:7], v0 offset:22528
    ds_read_b64_tr_b16 v[8:9], v0 offset:23040
    s_waitcnt lgkmcnt(8)
    v_mfma_f32_32x32x16_bf16 v[22:37], v[10:13], v[66:69], v[22:37]
    ds_read_b64_tr_b16 v[10:11], v0 offset:24576
    ds_read_b64_tr_b16 v[12:13], v0 offset:25088
    s_waitcnt lgkmcnt(8)
    v_mfma_f32_32x32x16_bf16 v[22:37], v[14:17], v[70:73], v[22:37]
    ds_read_b64_tr_b16 v[14:15], v0 offset:26624
    ds_read_b64_tr_b16 v[16:17], v0 offset:27136
    s_waitcnt lgkmcnt(8)
    v_mfma_f32_32x32x16_bf16 v[22:37], v[18:21], v[74:77], v[22:37]
    ds_read_b64_tr_b16 v[18:19], v0 offset:28672
    ds_read_b64_tr_b16 v[20:21], v0 offset:29184
    s_waitcnt lgkmcnt(8)
    v_mfma_f32_32x32x16_bf16 v[22:37], v[2:5], v[78:81], v[22:37]
    ds_read_b64_tr_b16 v[2:3], v0 offset:30720
    ds_read_b64_tr_b16 v[4:5], v0 offset:31232
    s_waitcnt lgkmcnt(8)
    v_mfma_f32_32x32x16_bf16 v[22:37], v[6:9], v[82:85], v[22:37]
    ds_read_b64_tr_b16 v[6:7], v0 offset:32768
    ds_read_b64_tr_b16 v[8:9], v0 offset:33280
    s_waitcnt lgkmcnt(8)
    v_mfma_f32_32x32x16_bf16 v[22:37], v[10:13], v[86:89], v[22:37]
    ds_read_b64_tr_b16 v[10:11], v0 offset:34816
    ds_read_b64_tr_b16 v[12:13], v0 offset:35328
    s_waitcnt lgkmcnt(8)
    v_mfma_f32_32x32x16_bf16 v[22:37], v[14:17], v[90:93], v[22:37]
    ds_read_b64_tr_b16 v[14:15], v0 offset:36864
    ds_read_b64_tr_b16 v[16:17], v0 offset:37376
    s_waitcnt lgkmcnt(8)
    v_mfma_f32_32x32x16_bf16 v[22:37], v[18:21], v[94:97], v[22:37]
    ds_read_b64_tr_b16 v[18:19], v0 offset:38912
    ds_read_b64_tr_b16 v[20:21], v0 offset:39424
    s_waitcnt lgkmcnt(8)
    v_mfma_f32_32x32x16_bf16 v[22:37], v[2:5], v[98:101], v[22:37]
    ds_read_b64_tr_b16 v[2:3], v0 offset:40960
    ds_read_b64_tr_b16 v[4:5], v0 offset:41472
    s_waitcnt lgkmcnt(8)
    v_mfma_f32_32x32x16_bf16 v[22:37], v[6:9], v[102:105], v[22:37]
    ds_read_b64_tr_b16 v[6:7], v0 offset:43008
    ds_read_b64_tr_b16 v[8:9], v0 offset:43520
    s_waitcnt lgkmcnt(8)
    v_mfma_f32_32x32x16_bf16 v[22:37], v[10:13], v[106:109], v[22:37]
    ds_read_b64_tr_b16 v[10:11], v0 offset:45056
    ds_read_b64_tr_b16 v[12:13], v0 offset:45568
    s_waitcnt lgkmcnt(8)
    v_mfma_f32_32x32x16_bf16 v[22:37], v[14:17], v[110:113], v[22:37]
    ds_read_b64_tr_b16 v[14:15], v0 offset:47104
    ds_read_b64_tr_b16 v[16:17], v0 offset:47616
    s_waitcnt lgkmcnt(8)
    v_mfma_f32_32x32x16_bf16 v[22:37], v[18:21], v[114:117], v[22:37]
    ds_read_b64_tr_b16 v[18:19], v0 offset:49152
    ds_read_b64_tr_b16 v[20:21], v0 offset:49664
    s_waitcnt lgkmcnt(8)
    v_mfma_f32_32x32x16_bf16 v[22:37], v[2:5], v[118:121], v[22:37]
    ds_read_b64_tr_b16 v[2:3], v0 offset:51200
    ds_read_b64_tr_b16 v[4:5], v0 offset:51712
    s_waitcnt lgkmcnt(8)
    v_mfma_f32_32x32x16_bf16 v[22:37], v[6:9], v[122:125], v[22:37]
    ds_read_b64_tr_b16 v[6:7], v0 offset:53248
    ds_read_b64_tr_b16 v[8:9], v0 offset:53760
    s_waitcnt lgkmcnt(8)
    v_mfma_f32_32x32x16_bf16 v[22:37], v[10:13], v[126:129], v[22:37]
    ds_read_b64_tr_b16 v[10:11], v0 offset:55296
    ds_read_b64_tr_b16 v[12:13], v0 offset:55808
    s_waitcnt lgkmcnt(8)
    v_mfma_f32_32x32x16_bf16 v[22:37], v[14:17], v[130:133], v[22:37]
    ds_read_b64_tr_b16 v[14:15], v0 offset:57344
    ds_read_b64_tr_b16 v[16:17], v0 offset:57856
    s_waitcnt lgkmcnt(8)
    v_mfma_f32_32x32x16_bf16 v[22:37], v[18:21], v[134:137], v[22:37]
    ds_read_b64_tr_b16 v[18:19], v0 offset:59392
    ds_read_b64_tr_b16 v[20:21], v0 offset:59904
    s_waitcnt lgkmcnt(8)
    v_mfma_f32_32x32x16_bf16 v[22:37], v[2:5], v[138:141], v[22:37]
    ds_read_b64_tr_b16 v[2:3], v0 offset:61440
    ds_read_b64_tr_b16 v[4:5], v0 offset:61952
    s_waitcnt lgkmcnt(8)
    v_mfma_f32_32x32x16_bf16 v[22:37], v[6:9], v[142:145], v[22:37]
    ds_read_b64_tr_b16 v[6:7], v0 offset:63488
    ds_read_b64_tr_b16 v[8:9], v0 offset:64000
    s_waitcnt lgkmcnt(8)
    v_mfma_f32_32x32x16_bf16 v[22:37], v[10:13], v[146:149], v[22:37]
    s_setprio 3
    v_add_u32 v10, 143360, v1
    s_setprio 0
    ds_read_b128 v[10:13], v10 offset:17408
    s_waitcnt lgkmcnt(7)
    v_mfma_f32_32x32x16_bf16 v[22:37], v[14:17], v[150:153], v[22:37]
    s_setprio 3
    v_and_b32 v14, 0x1ff, v1
    v_add_u32 v14, s90, v14
    s_setprio 0
    ds_read_b96 v[14:16], v14
    s_waitcnt lgkmcnt(6)
    v_mfma_f32_32x32x16_bf16 v[22:37], v[18:21], v[154:157], v[22:37]
    s_setprio 3
    v_mov_b32 v18, 155648
    v_mov_b32 v20, 1
    s_setprio 0
    ds_read_b32 v19, v18 offset:7784
    s_waitcnt lgkmcnt(5)
    v_mfma_f32_32x32x16_bf16 v[22:37], v[2:5], v[158:161], v[22:37]
    s_waitcnt lgkmcnt(3)
    v_mfma_f32_32x32x16_bf16 v[22:37], v[6:9], v[162:165], v[22:37]
    s_setprio 3
    s_waitcnt lgkmcnt(1)
    v_max3_u32 v21, v10, v12, v16
    v_cmp_eq_u32 vcc, -1, v21
    s_cbranch_vccnz F_CW1
F_CR1:
    v_perm_b32 v17, v16, v15, s79
    v_mov_b32 v16, v14
    v_xor_b32 v0, 0x10040, v0
    s_nop 0
    v_mfma_f32_32x32x16_bf16 v[22:37], v[10:13], v[14:17], v[22:37]
    s_mov_b64 exec, 1
    ds_add_u32 v18, v20 offset:7708
    s_mov_b64 exec, -1
    s_cmp_eq_u32 s76, 3
    s_cbranch_scc1 F_T3
    s_waitcnt lgkmcnt(0)
    v_readfirstlane_b32 s93, v19
    s_cmp_ge_u32 s93, 4
    s_cbranch_scc0 F_KW1
F_KR1:
    ds_read_b64_tr_b16 v[2:3], v0 offset:0
    ds_read_b64_tr_b16 v[4:5], v0 offset:512
    ds_read_b64_tr_b16 v[6:7], v0 offset:2048
    ds_read_b64_tr_b16 v[8:9], v0 offset:2560
    ds_read_b64_tr_b16 v[10:11], v0 offset:4096
    ds_read_b64_tr_b16 v[12:13], v0 offset:4608
    ds_read_b64_tr_b16 v[14:15], v0 offset:6144
    ds_read_b64_tr_b16 v[16:17], v0 offset:6656
    ds_read_b64_tr_b16 v[18:19], v0 offset:8192
    ds_read_b64_tr_b16 v[20:21], v0 offset:8704
    s_add_u32 s6, s60, 0
    v_mul_f32 v22, v22, |v22|
    v_mul_f32 v23, v23, |v23|
    v_cvt_pk_bf16_f32 v22, v22, v23
    v_pk_max_i16 v22, v22, 0
    v_mul_f32 v24, v24, |v24|
    v_mul_f32 v25, v25, |v25|
    v_cvt_pk_bf16_f32 v23, v24, v25
    v_pk_max_i16 v23, v23, 0
    v_mul_f32 v26, v26, |v26|
    v_mul_f32 v27, v27, |v27|
    v_cvt_pk_bf16_f32 v24, v26, v27
    v_pk_max_i16 v24, v24, 0
    s_branch SK19
ST19:
    s_branch F_K1
SK19:
    v_mul_f32 v28, v28, |v28|
    v_mul_f32 v29, v29, |v29|
    v_cvt_pk_bf16_f32 v25, v28, v29
    v_pk_max_i16 v25, v25, 0
    buffer_store_dwordx4 v[22:25], v1, s[16:19], s6 offen offset:2048 sc1
    v_mul_f32 v30, v30, |v30|
    v_mul_f32 v31, v31, |v31|
    v_cvt_pk_bf16_f32 v30, v30, v31
    v_pk_max_i16 v30, v30, 0
    v_mul_f32 v32, v32, |v32|
    v_mul_f32 v33, v33, |v33|
    v_cvt_pk_bf16_f32 v31, v32, v33
    v_pk_max_i16 v31, v31, 0
    v_mul_f32 v34, v34, |v34|
    v_mul_f32 v35, v35, |v35|
    v_cvt_pk_bf16_f32 v32, v34, v35
    v_pk_max_i16 v32, v32, 0
    v_mul_f32 v36, v36, |v36|
    v_mul_f32 v37, v37, |v37|
    v_cvt_pk_bf16_f32 v33, v36, v37
    v_pk_max_i16 v33, v33, 0
    buffer_store_dwordx4 v[30:33], v1, s[16:19], s6 offen offset:3072 sc1
    s_setprio 0
    s_waitcnt lgkmcnt(8)
    v_mfma_f32_32x32x16_bf16 v[22:37], v[2:5], v[38:41], 0
    ds_read_b64_tr_b16 v[2:3], v0 offset:10240
    ds_read_b64_tr_b16 v[4:5], v0 offset:10752
    s_waitcnt lgkmcnt(8)
    v_mfma_f32_32x32x16_bf16 v[22:37], v[6:9], v[42:45], v[22:37]
    ds_read_b64_tr_b16 v[6:7], v0 offset:12288
    ds_read_b64_tr_b16 v[8:9], v0 offset:12800
    s_waitcnt lgkmcnt(8)
    v_mfma_f32_32x32x16_bf16 v[22:37], v[10:13], v[46:49], v[22:37]
    ds_read_b64_tr_b16 v[10:11], v0 offset:14336
    ds_read_b64_tr_b16 v[12:13], v0 offset:14848
    s_waitcnt lgkmcnt(8)
    v_mfma_f32_32x32x16_bf16 v[22:37], v[14:17], v[50:53], v[22:37]
    ds_read_b64_tr_b16 v[14:15], v0 offset:16384
    ds_read_b64_tr_b16 v[16:17], v0 offset:16896
    s_waitcnt lgkmcnt(8)
    v_mfma_f32_32x32x16_bf16 v[22:37], v[18:21], v[54:57], v[22:37]
    ds_read_b64_tr_b16 v[18:19], v0 offset:18432
    ds_read_b64_tr_b16 v[20:21], v0 offset:18944
    s_waitcnt lgkmcnt(8)
    v_mfma_f32_32x32x16_bf16 v[22:37], v[2:5], v[58:61], v[22:37]
    ds_read_b64_tr_b16 v[2:3], v0 offset:20480
    ds_read_b64_tr_b16 v[4:5], v0 offset:20992
    s_waitcnt lgkmcnt(8)
    v_mfma_f32_32x32x16_bf16 v[22:37], v[6:9], v[62:65], v[22:37]
    ds_read_b64_tr_b16 v[6:7], v0 offset:22528
    ds_read_b64_tr_b16 v[8:9], v0 offset:23040
    s_waitcnt lgkmcnt(8)
    v_mfma_f32_32x32x16_bf16 v[22:37], v[10:13], v[66:69], v[22:37]
    ds_read_b64_tr_b16 v[10:11], v0 offset:24576
    ds_read_b64_tr_b16 v[12:13], v0 offset:25088
    s_waitcnt lgkmcnt(8)
    v_mfma_f32_32x32x16_bf16 v[22:37], v[14:17], v[70:73], v[22:37]
    ds_read_b64_tr_b16 v[14:15], v0 offset:26624
    ds_read_b64_tr_b16 v[16:17], v0 offset:27136
    s_waitcnt lgkmcnt(8)
    v_mfma_f32_32x32x16_bf16 v[22:37], v[18:21], v[74:77], v[22:37]
    ds_read_b64_tr_b16 v[18:19], v0 offset:28672
    ds_read_b64_tr_b16 v[20:21], v0 offset:29184
    s_waitcnt lgkmcnt(8)
    v_mfma_f32_32x32x16_bf16 v[22:37], v[2:5], v[78:81], v[22:37]
    ds_read_b64_tr_b16 v[2:3], v0 offset:30720
    ds_read_b64_tr_b16 v[4:5], v0 offset:31232
    s_waitcnt lgkmcnt(8)
    v_mfma_f32_32x32x16_bf16 v[22:37], v[6:9], v[82:85], v[22:37]
    ds_read_b64_tr_b16 v[6:7], v0 offset:32768
    ds_read_b64_tr_b16 v[8:9], v0 offset:33280
    s_waitcnt lgkmcnt(8)
    v_mfma_f32_32x32x16_bf16 v[22:37], v[10:13], v[86:89], v[22:37]
    ds_read_b64_tr_b16 v[10:11], v0 offset:34816
    ds_read_b64_tr_b16 v[12:13], v0 offset:35328
    s_waitcnt lgkmcnt(8)
    v_mfma_f32_32x32x16_bf16 v[22:37], v[14:17], v[90:93], v[22:37]
    ds_read_b64_tr_b16 v[14:15], v0 offset:36864
    ds_read_b64_tr_b16 v[16:17], v0 offset:37376
    s_waitcnt lgkmcnt(8)
    v_mfma_f32_32x32x16_bf16 v[22:37], v[18:21], v[94:97], v[22:37]
    ds_read_b64_tr_b16 v[18:19], v0 offset:38912
    ds_read_b64_tr_b16 v[20:21], v0 offset:39424
    s_waitcnt lgkmcnt(8)
    v_mfma_f32_32x32x16_bf16 v[22:37], v[2:5], v[98:101], v[22:37]
    ds_read_b64_tr_b16 v[2:3], v0 offset:40960
    ds_read_b64_tr_b16 v[4:5], v0 offset:41472
    s_waitcnt lgkmcnt(8)
    v_mfma_f32_32x32x16_bf16 v[22:37], v[6:9], v[102:105], v[22:37]
    ds_read_b64_tr_b16 v[6:7], v0 offset:43008
    ds_read_b64_tr_b16 v[8:9], v0 offset:43520
    s_waitcnt lgkmcnt(8)
    v_mfma_f32_32x32x16_bf16 v[22:37], v[10:13], v[106:109], v[22:37]
    ds_read_b64_tr_b16 v[10:11], v0 offset:45056
    ds_read_b64_tr_b16 v[12:13], v0 offset:45568
    s_waitcnt lgkmcnt(8)
    v_mfma_f32_32x32x16_bf16 v[22:37], v[14:17], v[110:113], v[22:37]
    ds_read_b64_tr_b16 v[14:15], v0 offset:47104
    ds_read_b64_tr_b16 v[16:17], v0 offset:47616
    s_waitcnt lgkmcnt(8)
    v_mfma_f32_32x32x16_bf16 v[22:37], v[18:21], v[114:117], v[22:37]
    ds_read_b64_tr_b16 v[18:19], v0 offset:49152
    ds_read_b64_tr_b16 v[20:21], v0 offset:49664
    s_waitcnt lgkmcnt(8)
    v_mfma_f32_32x32x16_bf16 v[22:37], v[2:5], v[118:121], v[22:37]
    ds_read_b64_tr_b16 v[2:3], v0 offset:51200
    ds_read_b64_tr_b16 v[4:5], v0 offset:51712
    s_waitcnt lgkmcnt(8)
    v_mfma_f32_32x32x16_bf16 v[22:37], v[6:9], v[122:125], v[22:37]
    ds_read_b64_tr_b16 v[6:7], v0 offset:53248
    s_branch SK20
.p2align 12
ST20:
    s_branch F_K1
SK20:
    ds_read_b64_tr_b16 v[8:9], v0 offset:53760
    s_waitcnt lgkmcnt(8)
    v_mfma_f32_32x32x16_bf16 v[22:37], v[10:13], v[126:129], v[22:37]
    ds_read_b64_tr_b16 v[10:11], v0 offset:55296
    ds_read_b64_tr_b16 v[12:13], v0 offset:55808
    s_waitcnt lgkmcnt(8)
    v_mfma_f32_32x32x16_bf16 v[22:37], v[14:17], v[130:133], v[22:37]
    ds_read_b64_tr_b16 v[14:15], v0 offset:57344
    ds_read_b64_tr_b16 v[16:17], v0 offset:57856
    s_waitcnt lgkmcnt(8)
    v_mfma_f32_32x32x16_bf16 v[22:37], v[18:21], v[134:137], v[22:37]
    ds_read_b64_tr_b16 v[18:19], v0 offset:59392
    ds_read_b64_tr_b16 v[20:21], v0 offset:59904
    s_waitcnt lgkmcnt(8)
    v_mfma_f32_32x32x16_bf16 v[22:37], v[2:5], v[138:141], v[22:37]
    ds_read_b64_tr_b16 v[2:3], v0 offset:61440
    ds_read_b64_tr_b16 v[4:5], v0 offset:61952
    s_waitcnt lgkmcnt(8)
    v_mfma_f32_32x32x16_bf16 v[22:37], v[6:9], v[142:145], v[22:37]
    ds_read_b64_tr_b16 v[6:7], v0 offset:63488
    ds_read_b64_tr_b16 v[8:9], v0 offset:64000
    s_waitcnt lgkmcnt(8)
    v_mfma_f32_32x32x16_bf16 v[22:37], v[10:13], v[146:149], v[22:37]
    s_setprio 3
    v_add_u32 v10, 143360, v1
    s_setprio 0
    ds_read_b128 v[10:13], v10 offset:2048
    s_waitcnt lgkmcnt(7)
    v_mfma_f32_32x32x16_bf16 v[22:37], v[14:17], v[150:153], v[22:37]
    s_setprio 3
    v_and_b32 v14, 0x1ff, v1
    v_add_u32 v14, s90, v14
    s_setprio 0
    ds_read_b96 v[14:16], v14
    s_waitcnt lgkmcnt(6)
    v_mfma_f32_32x32x16_bf16 v[22:37], v[18:21], v[154:157], v[22:37]
    s_setprio 3
    v_mov_b32 v18, 155648
    v_mov_b32 v20, 1
    s_setprio 0
    ds_read_b32 v19, v18 offset:7708
    s_waitcnt lgkmcnt(5)
    v_mfma_f32_32x32x16_bf16 v[22:37], v[2:5], v[158:161], v[22:37]
    s_waitcnt lgkmcnt(3)
    v_mfma_f32_32x32x16_bf16 v[22:37], v[6:9], v[162:165], v[22:37]
    s_waitcnt vmcnt(0)
    s_mov_b64 exec, 2
    buffer_store_dword v1, off, s[16:19], s88 sc1
    s_mov_b64 exec, -1
    s_setprio 3
    s_waitcnt lgkmcnt(1)
    v_max3_u32 v21, v10, v12, v16
    v_cmp_eq_u32 vcc, -1, v21
    s_cbranch_vccnz F_CW2
F_CR2:
    v_perm_b32 v17, v16, v15, s79
    v_mov_b32 v16, v14
    v_xor_b32 v0, 64, v0
    s_nop 0
    v_mfma_f32_32x32x16_bf16 v[22:37], v[10:13], v[14:17], v[22:37]
    s_waitcnt lgkmcnt(0)
    v_readfirstlane_b32 s93, v19
    s_cmp_ge_u32 s93, 5
    s_cbranch_scc0 F_KW2
F_KR2:
    ds_read_b64_tr_b16 v[2:3], v0 offset:0
    ds_read_b64_tr_b16 v[4:5], v0 offset:512
    ds_read_b64_tr_b16 v[6:7], v0 offset:2048
    ds_read_b64_tr_b16 v[8:9], v0 offset:2560
    ds_read_b64_tr_b16 v[10:11], v0 offset:4096
    ds_read_b64_tr_b16 v[12:13], v0 offset:4608
    ds_read_b64_tr_b16 v[14:15], v0 offset:6144
    ds_read_b64_tr_b16 v[16:17], v0 offset:6656
    ds_read_b64_tr_b16 v[18:19], v0 offset:8192
    ds_read_b64_tr_b16 v[20:21], v0 offset:8704
    s_add_u32 s6, s60, 16384
    v_mul_f32 v22, v22, |v22|
    v_mul_f32 v23, v23, |v23|
    v_cvt_pk_bf16_f32 v22, v22, v23
    v_pk_max_i16 v22, v22, 0
    v_mul_f32 v24, v24, |v24|
    v_mul_f32 v25, v25, |v25|
    v_cvt_pk_bf16_f32 v23, v24, v25
    v_pk_max_i16 v23, v23, 0
    v_mul_f32 v26, v26, |v26|
    v_mul_f32 v27, v27, |v27|
    v_cvt_pk_bf16_f32 v24, v26, v27
    v_pk_max_i16 v24, v24, 0
    v_mul_f32 v28, v28, |v28|
    v_mul_f32 v29, v29, |v29|
    v_cvt_pk_bf16_f32 v25, v28, v29
    v_pk_max_i16 v25, v25, 0
    buffer_store_dwordx4 v[22:25], v1, s[16:19], s6 offen offset:0 sc1
    v_mul_f32 v30, v30, |v30|
    v_mul_f32 v31, v31, |v31|
    v_cvt_pk_bf16_f32 v30, v30, v31
    v_pk_max_i16 v30, v30, 0
    v_mul_f32 v32, v32, |v32|
    v_mul_f32 v33, v33, |v33|
    v_cvt_pk_bf16_f32 v31, v32, v33
    v_pk_max_i16 v31, v31, 0
    v_mul_f32 v34, v34, |v34|
    v_mul_f32 v35, v35, |v35|
    v_cvt_pk_bf16_f32 v32, v34, v35
    v_pk_max_i16 v32, v32, 0
    v_mul_f32 v36, v36, |v36|
    v_mul_f32 v37, v37, |v37|
    v_cvt_pk_bf16_f32 v33, v36, v37
    v_pk_max_i16 v33, v33, 0
    buffer_store_dwordx4 v[30:33], v1, s[16:19], s6 offen offset:1024 sc1
    s_setprio 0
    s_waitcnt lgkmcnt(8)
    v_mfma_f32_32x32x16_bf16 v[22:37], v[2:5], v[38:41], 0
    ds_read_b64_tr_b16 v[2:3], v0 offset:10240
    ds_read_b64_tr_b16 v[4:5], v0 offset:10752
    s_waitcnt lgkmcnt(8)
    v_mfma_f32_32x32x16_bf16 v[22:37], v[6:9], v[42:45], v[22:37]
    ds_read_b64_tr_b16 v[6:7], v0 offset:12288
    ds_read_b64_tr_b16 v[8:9], v0 offset:12800
    s_add_u32 m0, s63, 0
    s_add_u32 s6, s80, 0
    s_and_b32 s6, s6, 3
    s_lshl_b32 s6, s6, 16
    s_add_u32 s81, s66, s6
    buffer_load_dwordx4 v166, s[12:15], s81 offen lds
    s_add_u32 s6, s81, 7168
    buffer_load_dwordx4 v166, s[12:15], s6 offen offset:1024 lds
    s_waitcnt lgkmcnt(8)
    v_mfma_f32_32x32x16_bf16 v[22:37], v[10:13], v[46:49], v[22:37]
    ds_read_b64_tr_b16 v[10:11], v0 offset:14336
    ds_read_b64_tr_b16 v[12:13], v0 offset:14848
    s_waitcnt lgkmcnt(8)
    v_mfma_f32_32x32x16_bf16 v[22:37], v[14:17], v[50:53], v[22:37]
    ds_read_b64_tr_b16 v[14:15], v0 offset:16384
    ds_read_b64_tr_b16 v[16:17], v0 offset:16896
    s_waitcnt lgkmcnt(8)
    v_mfma_f32_32x32x16_bf16 v[22:37], v[18:21], v[54:57], v[22:37]
    ds_read_b64_tr_b16 v[18:19], v0 offset:18432
    ds_read_b64_tr_b16 v[20:21], v0 offset:18944
    s_waitcnt lgkmcnt(8)
    v_mfma_f32_32x32x16_bf16 v[22:37], v[2:5], v[58:61], v[22:37]
    ds_read_b64_tr_b16 v[2:3], v0 offset:20480
    ds_read_b64_tr_b16 v[4:5], v0 offset:20992
    s_add_u32 m0, s63, 2048
    s_add_u32 s81, s81, 16384
    buffer_load_dwordx4 v166, s[12:15], s81 offen lds
    s_add_u32 s6, s81, 7168
    buffer_load_dwordx4 v166, s[12:15], s6 offen offset:1024 lds
    s_waitcnt lgkmcnt(8)
    v_mfma_f32_32x32x16_bf16 v[22:37], v[6:9], v[62:65], v[22:37]
    ds_read_b64_tr_b16 v[6:7], v0 offset:22528
    ds_read_b64_tr_b16 v[8:9], v0 offset:23040
    s_waitcnt lgkmcnt(8)
    v_mfma_f32_32x32x16_bf16 v[22:37], v[10:13], v[66:69], v[22:37]
    ds_read_b64_tr_b16 v[10:11], v0 offset:24576
    ds_read_b64_tr_b16 v[12:13], v0 offset:25088
    s_waitcnt lgkmcnt(8)
    v_mfma_f32_32x32x16_bf16 v[22:37], v[14:17], v[70:73], v[22:37]
    ds_read_b64_tr_b16 v[14:15], v0 offset:26624
    ds_read_b64_tr_b16 v[16:17], v0 offset:27136
    s_waitcnt lgkmcnt(8)
    v_mfma_f32_32x32x16_bf16 v[22:37], v[18:21], v[74:77], v[22:37]
    s_branch SK21
ST21:
    s_branch F_K1
SK21:
    ds_read_b64_tr_b16 v[18:19], v0 offset:28672
    ds_read_b64_tr_b16 v[20:21], v0 offset:29184
    s_add_u32 m0, s63, 4096
    s_add_u32 s81, s81, 16384
    buffer_load_dwordx4 v166, s[12:15], s81 offen lds
    s_add_u32 s6, s81, 7168
    buffer_load_dwordx4 v166, s[12:15], s6 offen offset:1024 lds
    s_waitcnt lgkmcnt(8)
    v_mfma_f32_32x32x16_bf16 v[22:37], v[2:5], v[78:81], v[22:37]
    ds_read_b64_tr_b16 v[2:3], v0 offset:30720
    ds_read_b64_tr_b16 v[4:5], v0 offset:31232
    s_waitcnt lgkmcnt(8)
    v_mfma_f32_32x32x16_bf16 v[22:37], v[6:9], v[82:85], v[22:37]
    ds_read_b64_tr_b16 v[6:7], v0 offset:32768
    ds_read_b64_tr_b16 v[8:9], v0 offset:33280
    s_waitcnt lgkmcnt(8)
    v_mfma_f32_32x32x16_bf16 v[22:37], v[10:13], v[86:89], v[22:37]
    ds_read_b64_tr_b16 v[10:11], v0 offset:34816
    ds_read_b64_tr_b16 v[12:13], v0 offset:35328
    s_waitcnt lgkmcnt(8)
    v_mfma_f32_32x32x16_bf16 v[22:37], v[14:17], v[90:93], v[22:37]
    ds_read_b64_tr_b16 v[14:15], v0 offset:36864
    ds_read_b64_tr_b16 v[16:17], v0 offset:37376
    s_add_u32 m0, s63, 6144
    s_add_u32 s81, s81, 16384
    buffer_load_dwordx4 v166, s[12:15], s81 offen lds
    s_add_u32 s6, s81, 7168
    buffer_load_dwordx4 v166, s[12:15], s6 offen offset:1024 lds
    s_waitcnt lgkmcnt(8)
    v_mfma_f32_32x32x16_bf16 v[22:37], v[18:21], v[94:97], v[22:37]
    ds_read_b64_tr_b16 v[18:19], v0 offset:38912
    ds_read_b64_tr_b16 v[20:21], v0 offset:39424
    s_waitcnt lgkmcnt(8)
    v_mfma_f32_32x32x16_bf16 v[22:37], v[2:5], v[98:101], v[22:37]
    ds_read_b64_tr_b16 v[2:3], v0 offset:40960
    ds_read_b64_tr_b16 v[4:5], v0 offset:41472
    s_waitcnt lgkmcnt(8)
    v_mfma_f32_32x32x16_bf16 v[22:37], v[6:9], v[102:105], v[22:37]
    ds_read_b64_tr_b16 v[6:7], v0 offset:43008
    ds_read_b64_tr_b16 v[8:9], v0 offset:43520
    s_waitcnt lgkmcnt(8)
    v_mfma_f32_32x32x16_bf16 v[22:37], v[10:13], v[106:109], v[22:37]
    ds_read_b64_tr_b16 v[10:11], v0 offset:45056
    ds_read_b64_tr_b16 v[12:13], v0 offset:45568
    s_add_u32 m0, s63, 8192
    s_add_u32 s6, s80, 1
    s_and_b32 s6, s6, 3
    s_lshl_b32 s6, s6, 16
    s_add_u32 s81, s66, s6
    buffer_load_dwordx4 v166, s[12:15], s81 offen lds
    s_add_u32 s6, s81, 7168
    buffer_load_dwordx4 v166, s[12:15], s6 offen offset:1024 lds
    s_waitcnt lgkmcnt(8)
    v_mfma_f32_32x32x16_bf16 v[22:37], v[14:17], v[110:113], v[22:37]
    ds_read_b64_tr_b16 v[14:15], v0 offset:47104
    ds_read_b64_tr_b16 v[16:17], v0 offset:47616
    s_waitcnt lgkmcnt(8)
    v_mfma_f32_32x32x16_bf16 v[22:37], v[18:21], v[114:117], v[22:37]
    ds_read_b64_tr_b16 v[18:19], v0 offset:49152
    ds_read_b64_tr_b16 v[20:21], v0 offset:49664
    s_waitcnt lgkmcnt(8)
    v_mfma_f32_32x32x16_bf16 v[22:37], v[2:5], v[118:121], v[22:37]
    ds_read_b64_tr_b16 v[2:3], v0 offset:51200
    ds_read_b64_tr_b16 v[4:5], v0 offset:51712
    s_waitcnt lgkmcnt(8)
    v_mfma_f32_32x32x16_bf16 v[22:37], v[6:9], v[122:125], v[22:37]
    ds_read_b64_tr_b16 v[6:7], v0 offset:53248
    ds_read_b64_tr_b16 v[8:9], v0 offset:53760
    s_add_u32 m0, s63, 10240
    s_add_u32 s81, s81, 16384
    buffer_load_dwordx4 v166, s[12:15], s81 offen lds
    s_add_u32 s6, s81, 7168
    buffer_load_dwordx4 v166, s[12:15], s6 offen offset:1024 lds
    s_waitcnt lgkmcnt(8)
    v_mfma_f32_32x32x16_bf16 v[22:37], v[10:13], v[126:129], v[22:37]
    ds_read_b64_tr_b16 v[10:11], v0 offset:55296
    ds_read_b64_tr_b16 v[12:13], v0 offset:55808
    s_waitcnt lgkmcnt(8)
    v_mfma_f32_32x32x16_bf16 v[22:37], v[14:17], v[130:133], v[22:37]
    ds_read_b64_tr_b16 v[14:15], v0 offset:57344
    ds_read_b64_tr_b16 v[16:17], v0 offset:57856
    s_waitcnt lgkmcnt(8)
    v_mfma_f32_32x32x16_bf16 v[22:37], v[18:21], v[134:137], v[22:37]
    ds_read_b64_tr_b16 v[18:19], v0 offset:59392
    ds_read_b64_tr_b16 v[20:21], v0 offset:59904
    s_waitcnt lgkmcnt(8)
    v_mfma_f32_32x32x16_bf16 v[22:37], v[2:5], v[138:141], v[22:37]
    ds_read_b64_tr_b16 v[2:3], v0 offset:61440
    ds_read_b64_tr_b16 v[4:5], v0 offset:61952
    s_add_u32 m0, s63, 12288
    s_add_u32 s81, s81, 16384
    buffer_load_dwordx4 v166, s[12:15], s81 offen lds
    s_add_u32 s6, s81, 7168
    buffer_load_dwordx4 v166, s[12:15], s6 offen offset:1024 lds
    s_waitcnt lgkmcnt(8)
    v_mfma_f32_32x32x16_bf16 v[22:37], v[6:9], v[142:145], v[22:37]
    ds_read_b64_tr_b16 v[6:7], v0 offset:63488
    ds_read_b64_tr_b16 v[8:9], v0 offset:64000
    s_waitcnt lgkmcnt(8)
    v_mfma_f32_32x32x16_bf16 v[22:37], v[10:13], v[146:149], v[22:37]
    s_setprio 3
    v_add_u32 v10, 143360, v1
    s_setprio 0
    ds_read_b128 v[10:13], v10 offset:3072
    s_waitcnt lgkmcnt(7)
    v_mfma_f32_32x32x16_bf16 v[22:37], v[14:17], v[150:153], v[22:37]
    s_setprio 3
    v_and_b32 v14, 0x1ff, v1
    v_add_u32 v14, s90, v14
    s_setprio 0
    ds_read_b96 v[14:16], v14
    s_waitcnt lgkmcnt(6)
    v_mfma_f32_32x32x16_bf16 v[22:37], v[18:21], v[154:157], v[22:37]
    s_add_u32 m0, s63, 14336
    s_add_u32 s81, s81, 16384
    buffer_load_dwordx4 v166, s[12:15], s81 offen lds
    s_add_u32 s6, s81, 7168
    buffer_load_dwordx4 v166, s[12:15], s6 offen offset:1024 lds
    s_waitcnt lgkmcnt(4)
    v_mfma_f32_32x32x16_bf16 v[22:37], v[2:5], v[158:161], v[22:37]
    s_waitcnt lgkmcnt(2)
    v_mfma_f32_32x32x16_bf16 v[22:37], v[6:9], v[162:165], v[22:37]
    s_setprio 3
    s_waitcnt lgkmcnt(0)
    v_max3_u32 v21, v10, v12, v16
    v_cmp_eq_u32 vcc, -1, v21
    s_cbranch_vccnz F_CW3
F_CR3:
    v_perm_b32 v17, v16, v15, s79
    v_mov_b32 v16, v14
    s_nop 1
    v_mfma_f32_32x32x16_bf16 v[22:37], v[10:13], v[14:17], v[22:37]
    v_lshrrev_b32 v0, 4, v1
    v_and_b32 v2, 3, v0
    v_and_b32 v5, 4, v0
    v_lshl_add_u32 v2, v2, 11, v5
    buffer_load_dword v5, v2, s[16:19], s75 offen sc1
    s_add_u32 s6, s60, 16384
    s_nop 5
    v_mul_f32 v22, v22, |v22|
    v_mul_f32 v23, v23, |v23|
    v_cvt_pk_bf16_f32 v22, v22, v23
    v_pk_max_i16 v22, v22, 0
    v_mul_f32 v24, v24, |v24|
    v_mul_f32 v25, v25, |v25|
    v_cvt_pk_bf16_f32 v23, v24, v25
    v_pk_max_i16 v23, v23, 0
    v_mul_f32 v26, v26, |v26|
    v_mul_f32 v27, v27, |v27|
    v_cvt_pk_bf16_f32 v24, v26, v27
    v_pk_max_i16 v24, v24, 0
    v_mul_f32 v28, v28, |v28|
    v_mul_f32 v29, v29, |v29|
    v_cvt_pk_bf16_f32 v25, v28, v29
    v_pk_max_i16 v25, v25, 0
    buffer_store_dwordx4 v[22:25], v1, s[16:19], s6 offen offset:2048 sc1
    v_mul_f32 v30, v30, |v30|
    v_mul_f32 v31, v31, |v31|
    s_branch SK22
ST22:
    s_branch F_K1
SK22:
    v_cvt_pk_bf16_f32 v30, v30, v31
    v_pk_max_i16 v30, v30, 0
    v_mul_f32 v32, v32, |v32|
    v_mul_f32 v33, v33, |v33|
    v_cvt_pk_bf16_f32 v31, v32, v33
    v_pk_max_i16 v31, v31, 0
    v_mul_f32 v34, v34, |v34|
    v_mul_f32 v35, v35, |v35|
    v_cvt_pk_bf16_f32 v32, v34, v35
    v_pk_max_i16 v32, v32, 0
    v_mul_f32 v36, v36, |v36|
    v_mul_f32 v37, v37, |v37|
    v_cvt_pk_bf16_f32 v33, v36, v37
    v_pk_max_i16 v33, v33, 0
    buffer_store_dwordx4 v[30:33], v1, s[16:19], s6 offen offset:3072 sc1
    s_branch F_T4
F_CW0:
    s_mov_b32 s92, 320000
F_CL0:
    s_sleep 1
    v_add_u32 v10, 143360, v1
    v_and_b32 v14, 0x1ff, v1
    v_add_u32 v14, s90, v14
    ds_read_b128 v[10:13], v10 offset:16384
    ds_read_b128 v[14:17], v14
    s_sub_u32 s92, s92, 1
    s_waitcnt lgkmcnt(0)
    v_max3_u32 v21, v10, v12, v16
    v_cmp_eq_u32 vcc, -1, v21
    s_cbranch_vccz F_CR0
    s_cmp_lg_u32 s92, 0
    s_cbranch_scc1 F_CL0
    s_branch F_CR0
F_CW1:
    s_mov_b32 s92, 320000
F_CL1:
    s_sleep 1
    v_add_u32 v10, 143360, v1
    v_and_b32 v14, 0x1ff, v1
    v_add_u32 v14, s90, v14
    ds_read_b128 v[10:13], v10 offset:17408
    ds_read_b96 v[14:16], v14
    s_sub_u32 s92, s92, 1
    s_waitcnt lgkmcnt(0)
    v_max3_u32 v21, v10, v12, v16
    v_cmp_eq_u32 vcc, -1, v21
    s_cbranch_vccz F_CR1
    s_cmp_lg_u32 s92, 0
    s_cbranch_scc1 F_CL1
    s_branch F_CR1
F_KW1:
    s_mov_b32 s92, 320000
LL_1001:
    ds_read_b32 v19, v18 offset:7784
    s_waitcnt lgkmcnt(0)
    v_readfirstlane_b32 s93, v19
    s_cmp_ge_u32 s93, 4
    s_cbranch_scc1 LD_1002
    s_sleep 1
    s_sub_u32 s92, s92, 1
    s_cmp_lg_u32 s92, 0
    s_cbranch_scc1 LL_1001
LD_1002:
    s_branch F_KR1
F_CW2:
    s_mov_b32 s92, 320000
F_CL2:
    s_sleep 1
    v_add_u32 v10, 143360, v1
    v_and_b32 v14, 0x1ff, v1
    v_add_u32 v14, s90, v14
    ds_read_b128 v[10:13], v10 offset:2048
    ds_read_b96 v[14:16], v14
    s_sub_u32 s92, s92, 1
    s_waitcnt lgkmcnt(0)
    v_max3_u32 v21, v10, v12, v16
    v_cmp_eq_u32 vcc, -1, v21
    s_cbranch_vccz F_CR2
    s_cmp_lg_u32 s92, 0
    s_cbranch_scc1 F_CL2
    s_branch F_CR2
F_KW2:
    s_mov_b32 s92, 320000
LL_2001:
    ds_read_b32 v19, v18 offset:7708
    s_waitcnt lgkmcnt(0)
    v_readfirstlane_b32 s93, v19
    s_cmp_ge_u32 s93, 5
    s_cbranch_scc1 LD_2002
    s_sleep 1
    s_sub_u32 s92, s92, 1
    s_cmp_lg_u32 s92, 0
    s_cbranch_scc1 LL_2001
LD_2002:
    s_branch F_KR2
F_CW3:
    s_mov_b32 s92, 320000
F_CL3:
    s_sleep 1
    v_add_u32 v10, 143360, v1
    v_and_b32 v14, 0x1ff, v1
    v_add_u32 v14, s90, v14
    ds_read_b128 v[10:13], v10 offset:3072
    ds_read_b96 v[14:16], v14
    s_sub_u32 s92, s92, 1
    s_waitcnt lgkmcnt(0)
    v_max3_u32 v21, v10, v12, v16
    v_cmp_eq_u32 vcc, -1, v21
    s_cbranch_vccz F_CR3
    s_cmp_lg_u32 s92, 0
    s_cbranch_scc1 F_CL3
    s_branch F_CR3
F_T3:
    s_add_u32 s6, s60, 0
    s_nop 5
    v_mul_f32 v22, v22, |v22|
    v_mul_f32 v23, v23, |v23|
    v_cvt_pk_bf16_f32 v22, v22, v23
    v_pk_max_i16 v22, v22, 0
    v_mul_f32 v24, v24, |v24|
    v_mul_f32 v25, v25, |v25|
    v_cvt_pk_bf16_f32 v23, v24, v25
    v_pk_max_i16 v23, v23, 0
    v_mul_f32 v26, v26, |v26|
    v_mul_f32 v27, v27, |v27|
    v_cvt_pk_bf16_f32 v24, v26, v27
    v_pk_max_i16 v24, v24, 0
    v_mul_f32 v28, v28, |v28|
    v_mul_f32 v29, v29, |v29|
    v_cvt_pk_bf16_f32 v25, v28, v29
    v_pk_max_i16 v25, v25, 0
    buffer_store_dwordx4 v[22:25], v1, s[16:19], s6 offen offset:2048 sc1
    v_mul_f32 v30, v30, |v30|
    v_mul_f32 v31, v31, |v31|
    v_cvt_pk_bf16_f32 v30, v30, v31
    v_pk_max_i16 v30, v30, 0
    v_mul_f32 v32, v32, |v32|
    v_mul_f32 v33, v33, |v33|
    v_cvt_pk_bf16_f32 v31, v32, v33
    v_pk_max_i16 v31, v31, 0
    v_mul_f32 v34, v34, |v34|
    v_mul_f32 v35, v35, |v35|
    v_cvt_pk_bf16_f32 v32, v34, v35
    v_pk_max_i16 v32, v32, 0
    v_mul_f32 v36, v36, |v36|
    v_mul_f32 v37, v37, |v37|
    v_cvt_pk_bf16_f32 v33, v36, v37
    v_pk_max_i16 v33, v33, 0
    buffer_store_dwordx4 v[30:33], v1, s[16:19], s6 offen offset:3072 sc1
    s_waitcnt vmcnt(0)
    s_mov_b64 exec, 4
    buffer_store_dword v1, off, s[16:19], s88 sc1
    s_mov_b64 exec, -1
    s_mov_b32 s92, 320000
LL_42:
    ds_read_b32 v19, v18 offset:7708
    s_waitcnt lgkmcnt(0)
    v_readfirstlane_b32 s93, v19
    s_cmp_ge_u32 s93, 5
    s_cbranch_scc1 LD_43
    s_sleep 1
    s_sub_u32 s92, s92, 1
    s_cmp_lg_u32 s92, 0
    s_cbranch_scc1 LL_42
LD_43:
    s_waitcnt vmcnt(2)
    s_add_u32 m0, s63, 0
    s_add_u32 s6, s80, 0
    s_and_b32 s6, s6, 3
    s_lshl_b32 s6, s6, 16
    s_add_u32 s81, s66, s6
    buffer_load_dwordx4 v166, s[12:15], s81 offen lds
    s_add_u32 s6, s81, 7168
    buffer_load_dwordx4 v166, s[12:15], s6 offen offset:1024 lds
    s_waitcnt vmcnt(2)
    s_add_u32 m0, s63, 2048
    s_add_u32 s81, s81, 16384
    buffer_load_dwordx4 v166, s[12:15], s81 offen lds
    s_add_u32 s6, s81, 7168
    buffer_load_dwordx4 v166, s[12:15], s6 offen offset:1024 lds
    s_waitcnt vmcnt(2)
    s_add_u32 m0, s63, 4096
    s_add_u32 s81, s81, 16384
    buffer_load_dwordx4 v166, s[12:15], s81 offen lds
    s_add_u32 s6, s81, 7168
    buffer_load_dwordx4 v166, s[12:15], s6 offen offset:1024 lds
    s_waitcnt vmcnt(2)
    s_add_u32 m0, s63, 6144
    s_add_u32 s81, s81, 16384
    buffer_load_dwordx4 v166, s[12:15], s81 offen lds
    s_add_u32 s6, s81, 7168
    buffer_load_dwordx4 v166, s[12:15], s6 offen offset:1024 lds
    s_branch SK23
ST23:
    s_branch F_K1
SK23:
    s_waitcnt vmcnt(2)
    s_add_u32 m0, s63, 8192
    s_add_u32 s6, s80, 1
    s_and_b32 s6, s6, 3
    s_lshl_b32 s6, s6, 16
    s_add_u32 s81, s66, s6
    buffer_load_dwordx4 v166, s[12:15], s81 offen lds
    s_add_u32 s6, s81, 7168
    buffer_load_dwordx4 v166, s[12:15], s6 offen offset:1024 lds
    s_waitcnt vmcnt(2)
    s_add_u32 m0, s63, 10240
    s_add_u32 s81, s81, 16384
    buffer_load_dwordx4 v166, s[12:15], s81 offen lds
    s_add_u32 s6, s81, 7168
    buffer_load_dwordx4 v166, s[12:15], s6 offen offset:1024 lds
    s_waitcnt vmcnt(2)
    s_add_u32 m0, s63, 12288
    s_add_u32 s81, s81, 16384
    buffer_load_dwordx4 v166, s[12:15], s81 offen lds
    s_add_u32 s6, s81, 7168
    buffer_load_dwordx4 v166, s[12:15], s6 offen offset:1024 lds
    s_waitcnt vmcnt(2)
    s_add_u32 m0, s63, 14336
    s_add_u32 s81, s81, 16384
    buffer_load_dwordx4 v166, s[12:15], s81 offen lds
    s_add_u32 s6, s81, 7168
    buffer_load_dwordx4 v166, s[12:15], s6 offen offset:1024 lds
    v_lshrrev_b32 v0, 4, v1
    v_and_b32 v2, 3, v0
    v_and_b32 v5, 4, v0
    v_lshl_add_u32 v2, v2, 11, v5
    buffer_load_dword v5, v2, s[16:19], s75 offen sc1
    s_waitcnt vmcnt(0)
F_T4:
    v_mov_b32 v162, 155648
    v_mov_b32 v163, 1
    s_mov_b64 exec, 1
    ds_add_u32 v162, v163 offset:7692
    s_mov_b64 exec, -1
    v_lshrrev_b32 v7, 5, v0
    v_lshrrev_b32 v6, 2, v0
    v_and_b32 v6, 3, v6
    v_lshl_add_u32 v6, v7, 2, v6
    v_lshlrev_b32 v4, 7, v6
    v_and_b32 v6, 8, v0
    v_lshl_add_u32 v4, v6, 3, v4
    v_xor_b32 v4, s74, v4
    v_and_b32 v6, 1, v0
    v_lshl_add_u32 v4, v6, 5, v4
    v_and_b32 v6, 16, v0
    v_add_u32 v4, v6, v4
    v_and_b32 v6, 2, v0
    v_lshl_add_u32 v4, v6, 2, v4
    v_lshlrev_b32 v3, 5, v7
    v_add_u32 v12, s63, v4
    v_xor_b32 v13, 64, v12
    s_waitcnt vmcnt(2)
    v_cmp_le_u32 s[94:95], 16, v5
    s_cmp_eq_u64 s[94:95], -1
    s_cbranch_scc0 F_PW1
F_PR1:
    s_setprio 0
    s_mov_b32 s20, s40
    s_mov_b32 s21, s41
    s_mov_b32 s22, 524288
    s_mov_b32 s23, 0x00020000
    s_lshl_b32 s69, s3, 17
    s_add_u32 s69, s69, s77
    s_lshl_b32 s71, s3, 13
    s_add_u32 s6, s80, 0
    s_and_b32 s6, s6, 3
    s_lshl_b32 s6, s6, 12
    s_add_u32 s82, s64, s6
    s_add_u32 s83, s65, s6
    buffer_load_dwordx4 v[82:85], v1, s[16:19], s82 offen offset:0
    buffer_load_dwordx4 v[86:89], v1, s[16:19], s83 offen offset:0
    buffer_load_dwordx4 v[90:93], v1, s[16:19], s82 offen offset:1024
    buffer_load_dwordx4 v[94:97], v1, s[16:19], s83 offen offset:1024
    buffer_load_dword v9, v1, s[16:19], s59 offen sc1
    ds_read_b64_tr_b16 v[130:131], v12 offset:0
    ds_read_b64_tr_b16 v[132:133], v12 offset:1024
    ds_read_b64_tr_b16 v[134:135], v13 offset:0
    ds_read_b64_tr_b16 v[136:137], v13 offset:1024
    s_waitcnt vmcnt(4) lgkmcnt(0)
    v_mfma_f32_32x32x16_bf16 v[18:33], v[130:133], v[82:85], 0
    s_mov_b64 exec, 4
    buffer_store_dword v1, off, s[16:19], s88 sc1
    s_mov_b64 exec, -1
    s_add_u32 m0, s63, 0
    s_add_u32 s6, s80, 2
    s_and_b32 s6, s6, 3
    s_lshl_b32 s6, s6, 16
    s_add_u32 s81, s66, s6
    buffer_load_dwordx4 v166, s[12:15], s81 offen lds
    s_add_u32 s6, s81, 7168
    buffer_load_dwordx4 v166, s[12:15], s6 offen offset:1024 lds
    v_mfma_f32_32x32x16_bf16 v[34:49], v[134:137], v[82:85], 0
    s_waitcnt vmcnt(6)
    ds_read_b64_tr_b16 v[138:139], v12 offset:2048
    ds_read_b64_tr_b16 v[140:141], v12 offset:3072
    ds_read_b64_tr_b16 v[142:143], v13 offset:2048
    ds_read_b64_tr_b16 v[144:145], v13 offset:3072
    v_mfma_f32_32x32x16_bf16 v[50:65], v[130:133], v[86:89], 0
    v_mfma_f32_32x32x16_bf16 v[66:81], v[134:137], v[86:89], 0
    buffer_load_dwordx4 v[98:101], v1, s[16:19], s82 offen offset:2048
    buffer_load_dwordx4 v[102:105], v1, s[16:19], s83 offen offset:2048
    buffer_load_dwordx4 v[106:109], v1, s[16:19], s82 offen offset:3072
    buffer_load_dwordx4 v[110:113], v1, s[16:19], s83 offen offset:3072
    s_waitcnt vmcnt(9) lgkmcnt(0)
    v_mfma_f32_32x32x16_bf16 v[18:33], v[138:141], v[90:93], v[18:33]
    s_add_u32 m0, s63, 2048
    s_add_u32 s81, s81, 16384
    buffer_load_dwordx4 v166, s[12:15], s81 offen lds
    s_add_u32 s6, s81, 7168
    buffer_load_dwordx4 v166, s[12:15], s6 offen offset:1024 lds
    v_mfma_f32_32x32x16_bf16 v[34:49], v[142:145], v[90:93], v[34:49]
    s_waitcnt vmcnt(10)
    ds_read_b64_tr_b16 v[130:131], v12 offset:4096
    ds_read_b64_tr_b16 v[132:133], v12 offset:5120
    ds_read_b64_tr_b16 v[134:135], v13 offset:4096
    ds_read_b64_tr_b16 v[136:137], v13 offset:5120
    v_mfma_f32_32x32x16_bf16 v[50:65], v[138:141], v[94:97], v[50:65]
    v_mfma_f32_32x32x16_bf16 v[66:81], v[142:145], v[94:97], v[66:81]
    s_add_u32 s6, s80, 1
    s_and_b32 s6, s6, 3
    s_lshl_b32 s6, s6, 12
    s_add_u32 s82, s64, s6
    s_add_u32 s83, s65, s6
    buffer_load_dwordx4 v[114:117], v1, s[16:19], s82 offen offset:0
    buffer_load_dwordx4 v[118:121], v1, s[16:19], s83 offen offset:0
    s_branch SK24
.p2align 12
ST24:
    s_branch F_K1
SK24:
    buffer_load_dwordx4 v[122:125], v1, s[16:19], s82 offen offset:1024
    buffer_load_dwordx4 v[126:129], v1, s[16:19], s83 offen offset:1024
    s_waitcnt vmcnt(9) lgkmcnt(0)
    v_mfma_f32_32x32x16_bf16 v[18:33], v[130:133], v[98:101], v[18:33]
    s_add_u32 m0, s63, 4096
    s_add_u32 s81, s81, 16384
    buffer_load_dwordx4 v166, s[12:15], s81 offen lds
    s_add_u32 s6, s81, 7168
    buffer_load_dwordx4 v166, s[12:15], s6 offen offset:1024 lds
    v_mfma_f32_32x32x16_bf16 v[34:49], v[134:137], v[98:101], v[34:49]
    s_waitcnt vmcnt(10)
    ds_read_b64_tr_b16 v[138:139], v12 offset:6144
    ds_read_b64_tr_b16 v[140:141], v12 offset:7168
    ds_read_b64_tr_b16 v[142:143], v13 offset:6144
    ds_read_b64_tr_b16 v[144:145], v13 offset:7168
    v_mfma_f32_32x32x16_bf16 v[50:65], v[130:133], v[102:105], v[50:65]
    v_mfma_f32_32x32x16_bf16 v[66:81], v[134:137], v[102:105], v[66:81]
    buffer_load_dwordx4 v[82:85], v1, s[16:19], s82 offen offset:2048
    buffer_load_dwordx4 v[86:89], v1, s[16:19], s83 offen offset:2048
    buffer_load_dwordx4 v[90:93], v1, s[16:19], s82 offen offset:3072
    buffer_load_dwordx4 v[94:97], v1, s[16:19], s83 offen offset:3072
    s_waitcnt vmcnt(13) lgkmcnt(0)
    v_mfma_f32_32x32x16_bf16 v[18:33], v[138:141], v[106:109], v[18:33]
    s_add_u32 m0, s63, 6144
    s_add_u32 s81, s81, 16384
    buffer_load_dwordx4 v166, s[12:15], s81 offen lds
    s_add_u32 s6, s81, 7168
    buffer_load_dwordx4 v166, s[12:15], s6 offen offset:1024 lds
    v_mfma_f32_32x32x16_bf16 v[34:49], v[142:145], v[106:109], v[34:49]
    s_waitcnt vmcnt(14)
    ds_read_b64_tr_b16 v[130:131], v12 offset:8192
    ds_read_b64_tr_b16 v[132:133], v12 offset:9216
    ds_read_b64_tr_b16 v[134:135], v13 offset:8192
    ds_read_b64_tr_b16 v[136:137], v13 offset:9216
    v_mfma_f32_32x32x16_bf16 v[50:65], v[138:141], v[110:113], v[50:65]
    v_mfma_f32_32x32x16_bf16 v[66:81], v[142:145], v[110:113], v[66:81]
    s_add_u32 s6, s80, 2
    s_and_b32 s6, s6, 3
    s_lshl_b32 s6, s6, 12
    s_add_u32 s82, s64, s6
    s_add_u32 s83, s65, s6
    buffer_load_dwordx4 v[98:101], v1, s[16:19], s82 offen offset:0
    buffer_load_dwordx4 v[102:105], v1, s[16:19], s83 offen offset:0
    buffer_load_dwordx4 v[106:109], v1, s[16:19], s82 offen offset:1024
    buffer_load_dwordx4 v[110:113], v1, s[16:19], s83 offen offset:1024
    s_waitcnt vmcnt(15) lgkmcnt(0)
    v_mfma_f32_32x32x16_bf16 v[18:33], v[130:133], v[114:117], v[18:33]
    s_add_u32 m0, s63, 8192
    s_add_u32 s6, s80, 3
    s_and_b32 s6, s6, 3
    s_lshl_b32 s6, s6, 16
    s_add_u32 s81, s66, s6
    buffer_load_dwordx4 v166, s[12:15], s81 offen lds
    s_add_u32 s6, s81, 7168
    buffer_load_dwordx4 v166, s[12:15], s6 offen offset:1024 lds
    v_mfma_f32_32x32x16_bf16 v[34:49], v[134:137], v[114:117], v[34:49]
    s_waitcnt vmcnt(16)
    ds_read_b64_tr_b16 v[138:139], v12 offset:10240
    ds_read_b64_tr_b16 v[140:141], v12 offset:11264
    ds_read_b64_tr_b16 v[142:143], v13 offset:10240
    ds_read_b64_tr_b16 v[144:145], v13 offset:11264
    v_mfma_f32_32x32x16_bf16 v[50:65], v[130:133], v[118:121], v[50:65]
    v_mfma_f32_32x32x16_bf16 v[66:81], v[134:137], v[118:121], v[66:81]
    buffer_load_dwordx4 v[114:117], v1, s[16:19], s82 offen offset:2048
    buffer_load_dwordx4 v[118:121], v1, s[16:19], s83 offen offset:2048
    s_waitcnt vmcnt(17) lgkmcnt(0)
    v_mfma_f32_32x32x16_bf16 v[18:33], v[138:141], v[122:125], v[18:33]
    s_add_u32 m0, s63, 10240
    s_add_u32 s81, s81, 16384
    buffer_load_dwordx4 v166, s[12:15], s81 offen lds
    s_add_u32 s6, s81, 7168
    buffer_load_dwordx4 v166, s[12:15], s6 offen offset:1024 lds
    v_mfma_f32_32x32x16_bf16 v[34:49], v[142:145], v[122:125], v[34:49]
    s_waitcnt vmcnt(18)
    ds_read_b64_tr_b16 v[130:131], v12 offset:12288
    ds_read_b64_tr_b16 v[132:133], v12 offset:13312
    ds_read_b64_tr_b16 v[134:135], v13 offset:12288
    ds_read_b64_tr_b16 v[136:137], v13 offset:13312
    v_mfma_f32_32x32x16_bf16 v[50:65], v[138:141], v[126:129], v[50:65]
    v_mfma_f32_32x32x16_bf16 v[66:81], v[142:145], v[126:129], v[66:81]
    buffer_load_dwordx4 v[122:125], v1, s[16:19], s82 offen offset:3072
    buffer_load_dwordx4 v[126:129], v1, s[16:19], s83 offen offset:3072
    s_waitcnt vmcnt(17) lgkmcnt(0)
    v_mfma_f32_32x32x16_bf16 v[18:33], v[130:133], v[82:85], v[18:33]
    s_add_u32 m0, s63, 12288
    s_add_u32 s81, s81, 16384
    buffer_load_dwordx4 v166, s[12:15], s81 offen lds
    s_add_u32 s6, s81, 7168
    buffer_load_dwordx4 v166, s[12:15], s6 offen offset:1024 lds
    v_mfma_f32_32x32x16_bf16 v[34:49], v[134:137], v[82:85], v[34:49]
    s_waitcnt vmcnt(18)
    ds_read_b64_tr_b16 v[138:139], v12 offset:14336
    ds_read_b64_tr_b16 v[140:141], v12 offset:15360
    ds_read_b64_tr_b16 v[142:143], v13 offset:14336
    ds_read_b64_tr_b16 v[144:145], v13 offset:15360
    v_mfma_f32_32x32x16_bf16 v[50:65], v[130:133], v[86:89], v[50:65]
    v_mfma_f32_32x32x16_bf16 v[66:81], v[134:137], v[86:89], v[66:81]
    s_add_u32 s6, s80, 3
    s_and_b32 s6, s6, 3
    s_lshl_b32 s6, s6, 12
    s_add_u32 s82, s64, s6
    s_add_u32 s83, s65, s6
    buffer_load_dwordx4 v[82:85], v1, s[16:19], s82 offen offset:0
    buffer_load_dwordx4 v[86:89], v1, s[16:19], s83 offen offset:0
    s_waitcnt vmcnt(19) lgkmcnt(0)
    v_mfma_f32_32x32x16_bf16 v[18:33], v[138:141], v[90:93], v[18:33]
    s_add_u32 m0, s63, 14336
    s_add_u32 s81, s81, 16384
    buffer_load_dwordx4 v166, s[12:15], s81 offen lds
    s_add_u32 s6, s81, 7168
    buffer_load_dwordx4 v166, s[12:15], s6 offen offset:1024 lds
    v_mfma_f32_32x32x16_bf16 v[34:49], v[142:145], v[90:93], v[34:49]
    s_waitcnt vmcnt(20)
    ds_read_b64_tr_b16 v[130:131], v12 offset:0
    ds_read_b64_tr_b16 v[132:133], v12 offset:1024
    ds_read_b64_tr_b16 v[134:135], v13 offset:0
    ds_read_b64_tr_b16 v[136:137], v13 offset:1024
    v_mfma_f32_32x32x16_bf16 v[50:65], v[138:141], v[94:97], v[50:65]
    v_mfma_f32_32x32x16_bf16 v[66:81], v[142:145], v[94:97], v[66:81]
    buffer_load_dword v5, v2, s[16:19], s75 offen sc1
    buffer_load_dwordx4 v[90:93], v1, s[16:19], s82 offen offset:1024
    buffer_load_dwordx4 v[94:97], v1, s[16:19], s83 offen offset:1024
    s_waitcnt vmcnt(20) lgkmcnt(0)
    v_mfma_f32_32x32x16_bf16 v[18:33], v[130:133], v[98:101], v[18:33]
    s_add_u32 m0, s63, 0
    s_add_u32 s6, s80, 4
    s_cmp_ge_u32 s6, 7
    s_cselect_b32 s7, 3, 0
    s_sub_u32 s6, s6, s7
    s_lshl_b32 s6, s6, 16
    s_add_u32 s81, s66, s6
    buffer_load_dwordx4 v166, s[12:15], s81 offen lds
    s_add_u32 s6, s81, 7168
    buffer_load_dwordx4 v166, s[12:15], s6 offen offset:1024 lds
    v_mfma_f32_32x32x16_bf16 v[34:49], v[134:137], v[98:101], v[34:49]
    s_waitcnt vmcnt(21)
    ds_read_b64_tr_b16 v[138:139], v12 offset:2048
    ds_read_b64_tr_b16 v[140:141], v12 offset:3072
    ds_read_b64_tr_b16 v[142:143], v13 offset:2048
    ds_read_b64_tr_b16 v[144:145], v13 offset:3072
    v_mfma_f32_32x32x16_bf16 v[50:65], v[130:133], v[102:105], v[50:65]
    v_mfma_f32_32x32x16_bf16 v[66:81], v[134:137], v[102:105], v[66:81]
    buffer_load_dwordx4 v[98:101], v1, s[16:19], s82 offen offset:2048
    buffer_load_dwordx4 v[102:105], v1, s[16:19], s83 offen offset:2048
    s_waitcnt vmcnt(22) lgkmcnt(0)
    v_mfma_f32_32x32x16_bf16 v[18:33], v[138:141], v[106:109], v[18:33]
    s_add_u32 m0, s63, 2048
    s_add_u32 s81, s81, 16384
    buffer_load_dwordx4 v166, s[12:15], s81 offen lds
    s_add_u32 s6, s81, 7168
    buffer_load_dwordx4 v166, s[12:15], s6 offen offset:1024 lds
    v_mfma_f32_32x32x16_bf16 v[34:49], v[142:145], v[106:109], v[34:49]
    s_waitcnt vmcnt(23)
    ds_read_b64_tr_b16 v[130:131], v12 offset:4096
    ds_read_b64_tr_b16 v[132:133], v12 offset:5120
    s_branch SK25
ST25:
    s_branch F_K1
SK25:
    ds_read_b64_tr_b16 v[134:135], v13 offset:4096
    ds_read_b64_tr_b16 v[136:137], v13 offset:5120
    v_mfma_f32_32x32x16_bf16 v[50:65], v[138:141], v[110:113], v[50:65]
    v_mfma_f32_32x32x16_bf16 v[66:81], v[142:145], v[110:113], v[66:81]
    buffer_load_dwordx4 v[106:109], v1, s[16:19], s82 offen offset:3072
    buffer_load_dwordx4 v[110:113], v1, s[16:19], s83 offen offset:3072
    s_waitcnt vmcnt(22) lgkmcnt(0)
    v_mfma_f32_32x32x16_bf16 v[18:33], v[130:133], v[114:117], v[18:33]
    s_add_u32 m0, s63, 4096
    s_add_u32 s81, s81, 16384
    buffer_load_dwordx4 v166, s[12:15], s81 offen lds
    s_add_u32 s6, s81, 7168
    buffer_load_dwordx4 v166, s[12:15], s6 offen offset:1024 lds
    v_mfma_f32_32x32x16_bf16 v[34:49], v[134:137], v[114:117], v[34:49]
    s_waitcnt vmcnt(23)
    ds_read_b64_tr_b16 v[138:139], v12 offset:6144
    ds_read_b64_tr_b16 v[140:141], v12 offset:7168
    ds_read_b64_tr_b16 v[142:143], v13 offset:6144
    ds_read_b64_tr_b16 v[144:145], v13 offset:7168
    v_mfma_f32_32x32x16_bf16 v[50:65], v[130:133], v[118:121], v[50:65]
    v_mfma_f32_32x32x16_bf16 v[66:81], v[134:137], v[118:121], v[66:81]
    s_setprio 3
    s_waitcnt vmcnt(12)
    v_cmp_le_u32 s[94:95], 32, v5
    s_cmp_eq_u64 s[94:95], -1
    s_cbranch_scc0 F_PW2
F_PR2:
    s_mov_b32 s92, 320000
LL_44:
    ds_read_b32 v6, v162 offset:7692
    s_waitcnt lgkmcnt(0)
    v_readfirstlane_b32 s93, v6
    s_cmp_ge_u32 s93, 12
    s_cbranch_scc1 LD_45
    s_sleep 1
    s_sub_u32 s92, s92, 1
    s_cmp_lg_u32 s92, 0
    s_cbranch_scc1 LL_44
LD_45:
    s_setprio 0
    s_add_u32 s6, s80, 4
    s_cmp_ge_u32 s6, 7
    s_cselect_b32 s7, 3, 0
    s_sub_u32 s6, s6, s7
    s_lshl_b32 s6, s6, 12
    s_add_u32 s82, s64, s6
    s_add_u32 s83, s65, s6
    buffer_load_dwordx4 v[114:117], v1, s[16:19], s82 offen offset:0
    buffer_load_dwordx4 v[118:121], v1, s[16:19], s83 offen offset:0
    s_waitcnt vmcnt(22) lgkmcnt(0)
    v_mfma_f32_32x32x16_bf16 v[18:33], v[138:141], v[122:125], v[18:33]
    s_add_u32 m0, s63, 6144
    s_add_u32 s81, s81, 16384
    buffer_load_dwordx4 v166, s[12:15], s81 offen lds
    s_add_u32 s6, s81, 7168
    buffer_load_dwordx4 v166, s[12:15], s6 offen offset:1024 lds
    v_mfma_f32_32x32x16_bf16 v[34:49], v[142:145], v[122:125], v[34:49]
    s_waitcnt vmcnt(23)
    ds_read_b64_tr_b16 v[130:131], v12 offset:8192
    ds_read_b64_tr_b16 v[132:133], v12 offset:9216
    ds_read_b64_tr_b16 v[134:135], v13 offset:8192
    ds_read_b64_tr_b16 v[136:137], v13 offset:9216
    v_mfma_f32_32x32x16_bf16 v[50:65], v[138:141], v[126:129], v[50:65]
    v_mfma_f32_32x32x16_bf16 v[66:81], v[142:145], v[126:129], v[66:81]
    buffer_load_dwordx4 v[122:125], v1, s[16:19], s82 offen offset:1024
    buffer_load_dwordx4 v[126:129], v1, s[16:19], s83 offen offset:1024
    s_waitcnt vmcnt(22) lgkmcnt(0)
    v_mfma_f32_32x32x16_bf16 v[18:33], v[130:133], v[82:85], v[18:33]
    s_add_u32 m0, s63, 8192
    s_add_u32 s6, s80, 5
    s_cmp_ge_u32 s6, 7
    s_cselect_b32 s7, 3, 0
    s_sub_u32 s6, s6, s7
    s_lshl_b32 s6, s6, 16
    s_add_u32 s81, s66, s6
    buffer_load_dwordx4 v166, s[12:15], s81 offen lds
    s_add_u32 s6, s81, 7168
    buffer_load_dwordx4 v166, s[12:15], s6 offen offset:1024 lds
    v_mfma_f32_32x32x16_bf16 v[34:49], v[134:137], v[82:85], v[34:49]
    s_waitcnt vmcnt(23)
    ds_read_b64_tr_b16 v[138:139], v12 offset:10240
    ds_read_b64_tr_b16 v[140:141], v12 offset:11264
    ds_read_b64_tr_b16 v[142:143], v13 offset:10240
    ds_read_b64_tr_b16 v[144:145], v13 offset:11264
    v_mfma_f32_32x32x16_bf16 v[50:65], v[130:133], v[86:89], v[50:65]
    v_mfma_f32_32x32x16_bf16 v[66:81], v[134:137], v[86:89], v[66:81]
    buffer_load_dwordx4 v[82:85], v1, s[16:19], s82 offen offset:2048
    buffer_load_dwordx4 v[86:89], v1, s[16:19], s83 offen offset:2048
    s_waitcnt vmcnt(21) lgkmcnt(0)
    v_mfma_f32_32x32x16_bf16 v[18:33], v[138:141], v[90:93], v[18:33]
    s_add_u32 m0, s63, 10240
    s_add_u32 s81, s81, 16384
    buffer_load_dwordx4 v166, s[12:15], s81 offen lds
    s_add_u32 s6, s81, 7168
    buffer_load_dwordx4 v166, s[12:15], s6 offen offset:1024 lds
    v_mfma_f32_32x32x16_bf16 v[34:49], v[142:145], v[90:93], v[34:49]
    s_waitcnt vmcnt(22)
    ds_read_b64_tr_b16 v[130:131], v12 offset:12288
    ds_read_b64_tr_b16 v[132:133], v12 offset:13312
    ds_read_b64_tr_b16 v[134:135], v13 offset:12288
    ds_read_b64_tr_b16 v[136:137], v13 offset:13312
    v_mfma_f32_32x32x16_bf16 v[50:65], v[138:141], v[94:97], v[50:65]
    v_mfma_f32_32x32x16_bf16 v[66:81], v[142:145], v[94:97], v[66:81]
    buffer_load_dwordx4 v[90:93], v1, s[16:19], s82 offen offset:3072
    buffer_load_dwordx4 v[94:97], v1, s[16:19], s83 offen offset:3072
    s_waitcnt vmcnt(21) lgkmcnt(0)
    v_mfma_f32_32x32x16_bf16 v[18:33], v[130:133], v[98:101], v[18:33]
    s_add_u32 m0, s63, 12288
    s_add_u32 s81, s81, 16384
    buffer_load_dwordx4 v166, s[12:15], s81 offen lds
    s_add_u32 s6, s81, 7168
    buffer_load_dwordx4 v166, s[12:15], s6 offen offset:1024 lds
    v_mfma_f32_32x32x16_bf16 v[34:49], v[134:137], v[98:101], v[34:49]
    s_waitcnt vmcnt(22)
    ds_read_b64_tr_b16 v[138:139], v12 offset:14336
    ds_read_b64_tr_b16 v[140:141], v12 offset:15360
    ds_read_b64_tr_b16 v[142:143], v13 offset:14336
    ds_read_b64_tr_b16 v[144:145], v13 offset:15360
    v_mfma_f32_32x32x16_bf16 v[50:65], v[130:133], v[102:105], v[50:65]
    v_mfma_f32_32x32x16_bf16 v[66:81], v[134:137], v[102:105], v[66:81]
    s_add_u32 s6, s80, 5
    s_cmp_ge_u32 s6, 7
    s_cselect_b32 s7, 3, 0
    s_sub_u32 s6, s6, s7
    s_lshl_b32 s6, s6, 12
    s_add_u32 s82, s64, s6
    s_add_u32 s83, s65, s6
    buffer_load_dwordx4 v[98:101], v1, s[16:19], s82 offen offset:0
    buffer_load_dwordx4 v[102:105], v1, s[16:19], s83 offen offset:0
    s_waitcnt vmcnt(21) lgkmcnt(0)
    v_mfma_f32_32x32x16_bf16 v[18:33], v[138:141], v[106:109], v[18:33]
    s_add_u32 m0, s63, 14336
    s_add_u32 s81, s81, 16384
    buffer_load_dwordx4 v166, s[12:15], s81 offen lds
    s_add_u32 s6, s81, 7168
    buffer_load_dwordx4 v166, s[12:15], s6 offen offset:1024 lds
    v_mfma_f32_32x32x16_bf16 v[34:49], v[142:145], v[106:109], v[34:49]
    s_waitcnt vmcnt(22)
    ds_read_b64_tr_b16 v[130:131], v12 offset:0
    ds_read_b64_tr_b16 v[132:133], v12 offset:1024
    ds_read_b64_tr_b16 v[134:135], v13 offset:0
    ds_read_b64_tr_b16 v[136:137], v13 offset:1024
    v_mfma_f32_32x32x16_bf16 v[50:65], v[138:141], v[110:113], v[50:65]
    v_mfma_f32_32x32x16_bf16 v[66:81], v[142:145], v[110:113], v[66:81]
    buffer_load_dwordx4 v[106:109], v1, s[16:19], s82 offen offset:1024
    buffer_load_dwordx4 v[110:113], v1, s[16:19], s83 offen offset:1024
    s_waitcnt vmcnt(21) lgkmcnt(0)
    v_mfma_f32_32x32x16_bf16 v[18:33], v[130:133], v[114:117], v[18:33]
    s_add_u32 m0, s63, 0
    s_add_u32 s6, s80, 6
    s_cmp_ge_u32 s6, 7
    s_cselect_b32 s7, 3, 0
    s_sub_u32 s6, s6, s7
    s_lshl_b32 s6, s6, 16
    s_add_u32 s81, s66, s6
    buffer_load_dwordx4 v166, s[12:15], s81 offen lds
    s_add_u32 s6, s81, 7168
    buffer_load_dwordx4 v166, s[12:15], s6 offen offset:1024 lds
    v_mfma_f32_32x32x16_bf16 v[34:49], v[134:137], v[114:117], v[34:49]
    s_waitcnt vmcnt(22)
    ds_read_b64_tr_b16 v[138:139], v12 offset:2048
    ds_read_b64_tr_b16 v[140:141], v12 offset:3072
    ds_read_b64_tr_b16 v[142:143], v13 offset:2048
    ds_read_b64_tr_b16 v[144:145], v13 offset:3072
    v_mfma_f32_32x32x16_bf16 v[50:65], v[130:133], v[118:121], v[50:65]
    v_mfma_f32_32x32x16_bf16 v[66:81], v[134:137], v[118:121], v[66:81]
    s_branch SK26
ST26:
    s_branch F_K1
SK26:
    buffer_load_dwordx4 v[114:117], v1, s[16:19], s82 offen offset:2048
    buffer_load_dwordx4 v[118:121], v1, s[16:19], s83 offen offset:2048
    s_waitcnt vmcnt(21) lgkmcnt(0)
    v_mfma_f32_32x32x16_bf16 v[18:33], v[138:141], v[122:125], v[18:33]
    s_add_u32 m0, s63, 2048
    s_add_u32 s81, s81, 16384
    buffer_load_dwordx4 v166, s[12:15], s81 offen lds
    s_add_u32 s6, s81, 7168
    buffer_load_dwordx4 v166, s[12:15], s6 offen offset:1024 lds
    s_add_u32 m0, s71, 65536
    s_add_u32 s68, s69, 0
    buffer_load_dwordx4 v166, s[20:23], s68 offen lds
    s_add_u32 s68, s68, 7168
    buffer_load_dwordx4 v166, s[20:23], s68 offen offset:1024 lds
    v_mfma_f32_32x32x16_bf16 v[34:49], v[142:145], v[122:125], v[34:49]
    s_waitcnt vmcnt(24)
    ds_read_b64_tr_b16 v[130:131], v12 offset:4096
    ds_read_b64_tr_b16 v[132:133], v12 offset:5120
    ds_read_b64_tr_b16 v[134:135], v13 offset:4096
    ds_read_b64_tr_b16 v[136:137], v13 offset:5120
    v_mfma_f32_32x32x16_bf16 v[50:65], v[138:141], v[126:129], v[50:65]
    v_mfma_f32_32x32x16_bf16 v[66:81], v[142:145], v[126:129], v[66:81]
    buffer_load_dwordx4 v[122:125], v1, s[16:19], s82 offen offset:3072
    buffer_load_dwordx4 v[126:129], v1, s[16:19], s83 offen offset:3072
    s_waitcnt vmcnt(23) lgkmcnt(0)
    v_mfma_f32_32x32x16_bf16 v[18:33], v[130:133], v[82:85], v[18:33]
    s_add_u32 m0, s63, 4096
    s_add_u32 s81, s81, 16384
    buffer_load_dwordx4 v166, s[12:15], s81 offen lds
    s_add_u32 s6, s81, 7168
    buffer_load_dwordx4 v166, s[12:15], s6 offen offset:1024 lds
    s_add_u32 m0, s71, 67584
    s_add_u32 s68, s69, 32768
    buffer_load_dwordx4 v166, s[20:23], s68 offen lds
    s_add_u32 s68, s68, 7168
    buffer_load_dwordx4 v166, s[20:23], s68 offen offset:1024 lds
    v_mfma_f32_32x32x16_bf16 v[34:49], v[134:137], v[82:85], v[34:49]
    s_waitcnt vmcnt(26)
    ds_read_b64_tr_b16 v[138:139], v12 offset:6144
    ds_read_b64_tr_b16 v[140:141], v12 offset:7168
    ds_read_b64_tr_b16 v[142:143], v13 offset:6144
    ds_read_b64_tr_b16 v[144:145], v13 offset:7168
    v_mfma_f32_32x32x16_bf16 v[50:65], v[130:133], v[86:89], v[50:65]
    v_mfma_f32_32x32x16_bf16 v[66:81], v[134:137], v[86:89], v[66:81]
    s_add_u32 s6, s80, 6
    s_cmp_ge_u32 s6, 7
    s_cselect_b32 s7, 3, 0
    s_sub_u32 s6, s6, s7
    s_lshl_b32 s6, s6, 12
    s_add_u32 s82, s64, s6
    s_add_u32 s83, s65, s6
    buffer_load_dwordx4 v[82:85], v1, s[16:19], s82 offen offset:0
    buffer_load_dwordx4 v[86:89], v1, s[16:19], s83 offen offset:0
    s_waitcnt vmcnt(25) lgkmcnt(0)
    v_mfma_f32_32x32x16_bf16 v[18:33], v[138:141], v[90:93], v[18:33]
    s_add_u32 m0, s63, 6144
    s_add_u32 s81, s81, 16384
    buffer_load_dwordx4 v166, s[12:15], s81 offen lds
    s_add_u32 s6, s81, 7168
    buffer_load_dwordx4 v166, s[12:15], s6 offen offset:1024 lds
    s_add_u32 m0, s71, 69632
    s_add_u32 s68, s69, 65536
    buffer_load_dwordx4 v166, s[20:23], s68 offen lds
    s_add_u32 s68, s68, 7168
    buffer_load_dwordx4 v166, s[20:23], s68 offen offset:1024 lds
    v_mfma_f32_32x32x16_bf16 v[34:49], v[142:145], v[90:93], v[34:49]
    s_waitcnt vmcnt(28)
    ds_read_b64_tr_b16 v[130:131], v12 offset:8192
    ds_read_b64_tr_b16 v[132:133], v12 offset:9216
    ds_read_b64_tr_b16 v[134:135], v13 offset:8192
    ds_read_b64_tr_b16 v[136:137], v13 offset:9216
    v_mfma_f32_32x32x16_bf16 v[50:65], v[138:141], v[94:97], v[50:65]
    v_mfma_f32_32x32x16_bf16 v[66:81], v[142:145], v[94:97], v[66:81]
    buffer_load_dwordx4 v[90:93], v1, s[16:19], s82 offen offset:1024
    buffer_load_dwordx4 v[94:97], v1, s[16:19], s83 offen offset:1024
    s_waitcnt vmcnt(27) lgkmcnt(0)
    v_mfma_f32_32x32x16_bf16 v[18:33], v[130:133], v[98:101], v[18:33]
    s_add_u32 m0, s71, 71680
    s_add_u32 s68, s69, 98304
    buffer_load_dwordx4 v166, s[20:23], s68 offen lds
    s_add_u32 s68, s68, 7168
    buffer_load_dwordx4 v166, s[20:23], s68 offen offset:1024 lds
    v_mfma_f32_32x32x16_bf16 v[34:49], v[134:137], v[98:101], v[34:49]
    s_waitcnt vmcnt(28)
    ds_read_b64_tr_b16 v[138:139], v12 offset:10240
    ds_read_b64_tr_b16 v[140:141], v12 offset:11264
    ds_read_b64_tr_b16 v[142:143], v13 offset:10240
    ds_read_b64_tr_b16 v[144:145], v13 offset:11264
    v_mfma_f32_32x32x16_bf16 v[50:65], v[130:133], v[102:105], v[50:65]
    v_mfma_f32_32x32x16_bf16 v[66:81], v[134:137], v[102:105], v[66:81]
    buffer_load_dwordx4 v[98:101], v1, s[16:19], s82 offen offset:2048
    buffer_load_dwordx4 v[102:105], v1, s[16:19], s83 offen offset:2048
    s_waitcnt vmcnt(27) lgkmcnt(0)
    v_mfma_f32_32x32x16_bf16 v[18:33], v[138:141], v[106:109], v[18:33]
    s_add_u32 m0, s71, 98304
    s_add_u32 s68, s69, 16384
    buffer_load_dwordx4 v166, s[20:23], s68 offen lds
    s_add_u32 s68, s68, 7168
    buffer_load_dwordx4 v166, s[20:23], s68 offen offset:1024 lds
    v_mfma_f32_32x32x16_bf16 v[34:49], v[142:145], v[106:109], v[34:49]
    s_waitcnt vmcnt(28)
    ds_read_b64_tr_b16 v[130:131], v12 offset:12288
    ds_read_b64_tr_b16 v[132:133], v12 offset:13312
    ds_read_b64_tr_b16 v[134:135], v13 offset:12288
    ds_read_b64_tr_b16 v[136:137], v13 offset:13312
    v_mfma_f32_32x32x16_bf16 v[50:65], v[138:141], v[110:113], v[50:65]
    v_mfma_f32_32x32x16_bf16 v[66:81], v[142:145], v[110:113], v[66:81]
    buffer_load_dwordx4 v[106:109], v1, s[16:19], s82 offen offset:3072
    buffer_load_dwordx4 v[110:113], v1, s[16:19], s83 offen offset:3072
    s_waitcnt vmcnt(27) lgkmcnt(0)
    v_mfma_f32_32x32x16_bf16 v[18:33], v[130:133], v[114:117], v[18:33]
    s_add_u32 m0, s71, 100352
    s_add_u32 s68, s69, 49152
    buffer_load_dwordx4 v166, s[20:23], s68 offen lds
    s_add_u32 s68, s68, 7168
    buffer_load_dwordx4 v166, s[20:23], s68 offen offset:1024 lds
    v_mfma_f32_32x32x16_bf16 v[34:49], v[134:137], v[114:117], v[34:49]
    s_waitcnt vmcnt(28)
    ds_read_b64_tr_b16 v[138:139], v12 offset:14336
    ds_read_b64_tr_b16 v[140:141], v12 offset:15360
    ds_read_b64_tr_b16 v[142:143], v13 offset:14336
    ds_read_b64_tr_b16 v[144:145], v13 offset:15360
    v_mfma_f32_32x32x16_bf16 v[50:65], v[130:133], v[118:121], v[50:65]
    v_mfma_f32_32x32x16_bf16 v[66:81], v[134:137], v[118:121], v[66:81]
    s_waitcnt vmcnt(23) lgkmcnt(0)
    v_mfma_f32_32x32x16_bf16 v[18:33], v[138:141], v[122:125], v[18:33]
    s_add_u32 m0, s71, 102400
    s_add_u32 s68, s69, 81920
    buffer_load_dwordx4 v166, s[20:23], s68 offen lds
    s_add_u32 s68, s68, 7168
    buffer_load_dwordx4 v166, s[20:23], s68 offen offset:1024 lds
    v_mfma_f32_32x32x16_bf16 v[34:49], v[142:145], v[122:125], v[34:49]
    s_waitcnt vmcnt(24)
    ds_read_b64_tr_b16 v[130:131], v12 offset:0
    ds_read_b64_tr_b16 v[132:133], v12 offset:1024
    ds_read_b64_tr_b16 v[134:135], v13 offset:0
    ds_read_b64_tr_b16 v[136:137], v13 offset:1024
    v_mfma_f32_32x32x16_bf16 v[50:65], v[138:141], v[126:129], v[50:65]
    v_mfma_f32_32x32x16_bf16 v[66:81], v[142:145], v[126:129], v[66:81]
    s_waitcnt vmcnt(19) lgkmcnt(0)
    v_mfma_f32_32x32x16_bf16 v[18:33], v[130:133], v[82:85], v[18:33]
    s_add_u32 m0, s71, 104448
    s_add_u32 s68, s69, 114688
    buffer_load_dwordx4 v166, s[20:23], s68 offen lds
    s_add_u32 s68, s68, 7168
    buffer_load_dwordx4 v166, s[20:23], s68 offen offset:1024 lds
    buffer_load_dwordx4 v[146:149], v3, s[24:27], s78 offen offset:0
    buffer_load_dwordx4 v[150:153], v3, s[24:27], s78 offen offset:16
    s_branch SK27
ST27:
    s_branch F_K1
SK27:
    v_mfma_f32_32x32x16_bf16 v[34:49], v[134:137], v[82:85], v[34:49]
    s_waitcnt vmcnt(22)
    ds_read_b64_tr_b16 v[138:139], v12 offset:2048
    ds_read_b64_tr_b16 v[140:141], v12 offset:3072
    ds_read_b64_tr_b16 v[142:143], v13 offset:2048
    ds_read_b64_tr_b16 v[144:145], v13 offset:3072
    v_mfma_f32_32x32x16_bf16 v[50:65], v[130:133], v[86:89], v[50:65]
    v_mfma_f32_32x32x16_bf16 v[66:81], v[134:137], v[86:89], v[66:81]
    s_waitcnt vmcnt(17) lgkmcnt(0)
    v_mfma_f32_32x32x16_bf16 v[18:33], v[138:141], v[90:93], v[18:33]
    v_mfma_f32_32x32x16_bf16 v[34:49], v[142:145], v[90:93], v[34:49]
    s_waitcnt vmcnt(16)
    ds_read_b64_tr_b16 v[130:131], v12 offset:4096
    ds_read_b64_tr_b16 v[132:133], v12 offset:5120
    ds_read_b64_tr_b16 v[134:135], v13 offset:4096
    ds_read_b64_tr_b16 v[136:137], v13 offset:5120
    v_mfma_f32_32x32x16_bf16 v[50:65], v[138:141], v[94:97], v[50:65]
    v_mfma_f32_32x32x16_bf16 v[66:81], v[142:145], v[94:97], v[66:81]
    s_waitcnt vmcnt(13) lgkmcnt(0)
    v_mfma_f32_32x32x16_bf16 v[18:33], v[130:133], v[98:101], v[18:33]
    v_mfma_f32_32x32x16_bf16 v[34:49], v[134:137], v[98:101], v[34:49]
    s_waitcnt vmcnt(12)
    ds_read_b64_tr_b16 v[138:139], v12 offset:6144
    ds_read_b64_tr_b16 v[140:141], v12 offset:7168
    ds_read_b64_tr_b16 v[142:143], v13 offset:6144
    ds_read_b64_tr_b16 v[144:145], v13 offset:7168
    v_mfma_f32_32x32x16_bf16 v[50:65], v[130:133], v[102:105], v[50:65]
    v_mfma_f32_32x32x16_bf16 v[66:81], v[134:137], v[102:105], v[66:81]
    s_waitcnt vmcnt(9) lgkmcnt(0)
    v_mfma_f32_32x32x16_bf16 v[18:33], v[138:141], v[106:109], v[18:33]
    v_mfma_f32_32x32x16_bf16 v[34:49], v[142:145], v[106:109], v[34:49]
    s_waitcnt vmcnt(8)
    v_mfma_f32_32x32x16_bf16 v[50:65], v[138:141], v[110:113], v[50:65]
    v_mfma_f32_32x32x16_bf16 v[66:81], v[142:145], v[110:113], v[66:81]
    s_setprio 0
    v_add_u32 v10, s63, v1
    s_nop 6
    ds_write_b128 v10, v[34:37] offset:0
    ds_write_b128 v10, v[38:41] offset:1024
    ds_write_b128 v10, v[42:45] offset:2048
    ds_write_b128 v10, v[46:49] offset:3072
    ds_write_b128 v10, v[50:53] offset:4096
    ds_write_b128 v10, v[54:57] offset:5120
    ds_write_b128 v10, v[58:61] offset:6144
    ds_write_b128 v10, v[62:65] offset:7168
    ds_write_b128 v10, v[66:69] offset:8192
    ds_write_b128 v10, v[70:73] offset:9216
    ds_write_b128 v10, v[74:77] offset:10240
    ds_write_b128 v10, v[78:81] offset:11264
    s_mov_b32 s8, s36
    s_mov_b32 s9, s37
    s_mov_b32 s10, 2097152
    s_mov_b32 s11, 0x00020000
    s_mov_b32 s28, s52
    s_mov_b32 s29, s53
    s_mov_b32 s30, 2097152
    s_mov_b32 s31, 0x00020000
    v_mov_b32 v6, -1
    ds_write_b32 v10, v6 offset:15360
    s_waitcnt vmcnt(2)
    s_mov_b64 exec, 1
    ds_add_u32 v162, v163 offset:7696
    s_mov_b64 exec, -1
    s_lshl2_add_u32 s72, s32, s73
    s_lshl_b32 s72, s72, 15
    s_add_u32 s79, s72, s78
    v_and_b32 v6, 31, v0
    v_lshl_add_u32 v11, v6, 10, v3
    s_lshl_b32 s6, s74, 8
    s_add_u32 s72, s72, s6
    s_add_u32 s6, s6, 65536
    v_add_u32 v12, s6, v4
    v_xor_b32 v13, 64, v12
    s_mov_b32 s71, 0
    buffer_load_dwordx4 v[14:17], v11, s[8:11], s79 offen offset:0
    buffer_load_dwordx4 v[2:5], v11, s[8:11], s79 offen offset:16
    s_add_u32 s64, s72, 16777216
    s_add_u32 s65, s72, 16781312
    s_add_u32 s66, s72, 16785408
    s_add_u32 s67, s72, 16789504
    s_mov_b32 s92, 320000
LL_46:
    ds_read_b32 v6, v162 offset:7696
    s_waitcnt lgkmcnt(0)
    v_readfirstlane_b32 s93, v6
    s_cmp_ge_u32 s93, 4
    s_cbranch_scc1 LD_47
    s_sleep 1
    s_sub_u32 s92, s92, 1
    s_cmp_lg_u32 s92, 0
    s_cbranch_scc1 LL_46
LD_47:
    s_waitcnt vmcnt(2)
    v_xor_b32 v8, 32768, v10
    ds_read_b128 v[34:37], v8 offset:0
    ds_read_b128 v[38:41], v8 offset:1024
    ds_read_b128 v[42:45], v8 offset:2048
    ds_read_b128 v[46:49], v8 offset:3072
    v_xor_b32 v8, 16384, v10
    ds_read_b128 v[50:53], v8 offset:4096
    ds_read_b128 v[54:57], v8 offset:5120
    ds_read_b128 v[58:61], v8 offset:6144
    ds_read_b128 v[62:65], v8 offset:7168
    v_xor_b32 v8, 49152, v10
    ds_read_b128 v[66:69], v8 offset:8192
    ds_read_b128 v[70:73], v8 offset:9216
    ds_read_b128 v[74:77], v8 offset:10240
    ds_read_b128 v[78:81], v8 offset:11264
    v_mul_f32 v9, v9, v9
    s_waitcnt lgkmcnt(8)
    v_add_f32 v18, v18, v34
    v_add_f32 v19, v19, v35
    v_add_f32 v20, v20, v36
    v_add_f32 v21, v21, v37
    v_add_f32 v22, v22, v38
    v_add_f32 v23, v23, v39
    v_add_f32 v24, v24, v40
    v_add_f32 v25, v25, v41
    v_add_f32 v26, v26, v42
    v_add_f32 v27, v27, v43
    v_add_f32 v28, v28, v44
    v_add_f32 v29, v29, v45
    v_add_f32 v30, v30, v46
    v_add_f32 v31, v31, v47
    v_add_f32 v32, v32, v48
    v_add_f32 v33, v33, v49
    s_waitcnt lgkmcnt(4)
    v_add_f32 v18, v18, v50
    v_add_f32 v19, v19, v51
    v_add_f32 v20, v20, v52
    s_branch SK28
.p2align 12
ST28:
    s_branch F_K1
SK28:
    v_add_f32 v21, v21, v53
    v_add_f32 v22, v22, v54
    v_add_f32 v23, v23, v55
    v_add_f32 v24, v24, v56
    v_add_f32 v25, v25, v57
    v_add_f32 v26, v26, v58
    v_add_f32 v27, v27, v59
    v_add_f32 v28, v28, v60
    v_add_f32 v29, v29, v61
    v_add_f32 v30, v30, v62
    v_add_f32 v31, v31, v63
    v_add_f32 v32, v32, v64
    v_add_f32 v33, v33, v65
    s_waitcnt lgkmcnt(0)
    s_mov_b64 exec, 1
    ds_add_u32 v162, v163 offset:7704
    s_mov_b64 exec, -1
    v_add_f32 v18, v18, v66
    v_add_f32 v19, v19, v67
    v_add_f32 v20, v20, v68
    v_add_f32 v21, v21, v69
    v_add_f32 v22, v22, v70
    v_add_f32 v23, v23, v71
    v_add_f32 v24, v24, v72
    v_add_f32 v25, v25, v73
    v_add_f32 v26, v26, v74
    v_add_f32 v27, v27, v75
    v_add_f32 v28, v28, v76
    v_add_f32 v29, v29, v77
    v_add_f32 v30, v30, v78
    v_add_f32 v31, v31, v79
    v_add_f32 v32, v32, v80
    v_add_f32 v33, v33, v81
    ds_read_b64_tr_b16 v[66:67], v12 offset:0
    ds_read_b64_tr_b16 v[68:69], v12 offset:1024
    ds_read_b64_tr_b16 v[70:71], v13 offset:0
    ds_read_b64_tr_b16 v[72:73], v13 offset:1024
    ds_read_b64_tr_b16 v[74:75], v12 offset:2048
    ds_read_b64_tr_b16 v[76:77], v12 offset:3072
    ds_read_b64_tr_b16 v[78:79], v13 offset:2048
    ds_read_b64_tr_b16 v[80:81], v13 offset:3072
    v_lshlrev_b32 v34, 16, v146
    v_fma_f32 v18, v18, v9, v34
    v_mul_f32 v38, 0xbfb8aa3b, v18
    v_and_b32 v35, s35, v146
    v_fma_f32 v19, v19, v9, v35
    v_mul_f32 v39, 0xbfb8aa3b, v19
    v_lshlrev_b32 v36, 16, v147
    v_fma_f32 v20, v20, v9, v36
    v_mul_f32 v40, 0xbfb8aa3b, v20
    v_and_b32 v37, s35, v147
    v_fma_f32 v21, v21, v9, v37
    v_mul_f32 v41, 0xbfb8aa3b, v21
    v_exp_f32 v38, v38
    v_exp_f32 v39, v39
    v_exp_f32 v40, v40
    v_exp_f32 v41, v41
    v_add_f32 v38, 1.0, v38
    v_add_f32 v39, 1.0, v39
    v_add_f32 v40, 1.0, v40
    v_add_f32 v41, 1.0, v41
    v_rcp_f32 v38, v38
    v_rcp_f32 v39, v39
    v_rcp_f32 v40, v40
    v_rcp_f32 v41, v41
    v_mul_f32 v18, v18, v38
    v_mul_f32 v19, v19, v39
    v_mul_f32 v20, v20, v40
    v_mul_f32 v21, v21, v41
    v_lshlrev_b32 v34, 16, v148
    v_fma_f32 v22, v22, v9, v34
    v_mul_f32 v38, 0xbfb8aa3b, v22
    v_and_b32 v35, s35, v148
    v_fma_f32 v23, v23, v9, v35
    v_mul_f32 v39, 0xbfb8aa3b, v23
    v_lshlrev_b32 v36, 16, v149
    v_fma_f32 v24, v24, v9, v36
    v_mul_f32 v40, 0xbfb8aa3b, v24
    v_and_b32 v37, s35, v149
    v_fma_f32 v25, v25, v9, v37
    v_mul_f32 v41, 0xbfb8aa3b, v25
    v_exp_f32 v38, v38
    v_exp_f32 v39, v39
    v_exp_f32 v40, v40
    v_exp_f32 v41, v41
    v_add_f32 v38, 1.0, v38
    v_add_f32 v39, 1.0, v39
    v_add_f32 v40, 1.0, v40
    v_add_f32 v41, 1.0, v41
    v_rcp_f32 v38, v38
    v_rcp_f32 v39, v39
    v_rcp_f32 v40, v40
    v_rcp_f32 v41, v41
    v_mul_f32 v22, v22, v38
    v_mul_f32 v23, v23, v39
    v_mul_f32 v24, v24, v40
    v_mul_f32 v25, v25, v41
    v_lshlrev_b32 v34, 16, v150
    v_fma_f32 v26, v26, v9, v34
    v_mul_f32 v38, 0xbfb8aa3b, v26
    v_and_b32 v35, s35, v150
    v_fma_f32 v27, v27, v9, v35
    v_mul_f32 v39, 0xbfb8aa3b, v27
    v_lshlrev_b32 v36, 16, v151
    v_fma_f32 v28, v28, v9, v36
    v_mul_f32 v40, 0xbfb8aa3b, v28
    v_and_b32 v37, s35, v151
    v_fma_f32 v29, v29, v9, v37
    v_mul_f32 v41, 0xbfb8aa3b, v29
    v_exp_f32 v38, v38
    v_exp_f32 v39, v39
    v_exp_f32 v40, v40
    v_exp_f32 v41, v41
    v_add_f32 v38, 1.0, v38
    v_add_f32 v39, 1.0, v39
    v_add_f32 v40, 1.0, v40
    v_add_f32 v41, 1.0, v41
    v_rcp_f32 v38, v38
    v_rcp_f32 v39, v39
    v_rcp_f32 v40, v40
    v_rcp_f32 v41, v41
    v_mul_f32 v26, v26, v38
    v_mul_f32 v27, v27, v39
    v_mul_f32 v28, v28, v40
    v_mul_f32 v29, v29, v41
    v_lshlrev_b32 v34, 16, v152
    v_fma_f32 v30, v30, v9, v34
    v_mul_f32 v38, 0xbfb8aa3b, v30
    v_and_b32 v35, s35, v152
    v_fma_f32 v31, v31, v9, v35
    v_mul_f32 v39, 0xbfb8aa3b, v31
    v_lshlrev_b32 v36, 16, v153
    v_fma_f32 v32, v32, v9, v36
    v_mul_f32 v40, 0xbfb8aa3b, v32
    v_and_b32 v37, s35, v153
    v_fma_f32 v33, v33, v9, v37
    v_mul_f32 v41, 0xbfb8aa3b, v33
    ds_read_b64 v[6:7], v162 offset:7792
    ds_read_b64_tr_b16 v[146:147], v12 offset:4096
    ds_read_b64_tr_b16 v[148:149], v12 offset:5120
    ds_read_b64_tr_b16 v[150:151], v13 offset:4096
    ds_read_b64_tr_b16 v[152:153], v13 offset:5120
    ds_read_b64_tr_b16 v[154:155], v12 offset:6144
    ds_read_b64_tr_b16 v[156:157], v12 offset:7168
    ds_read_b64_tr_b16 v[158:159], v13 offset:6144
    ds_read_b64_tr_b16 v[160:161], v13 offset:7168
    buffer_load_dwordx4 v[82:85], v1, s[16:19], s64 offen offset:0
    buffer_load_dwordx4 v[86:89], v1, s[16:19], s64 offen offset:2048
    buffer_load_dwordx4 v[90:93], v1, s[16:19], s65 offen offset:0
    buffer_load_dwordx4 v[94:97], v1, s[16:19], s65 offen offset:2048
    buffer_load_dwordx4 v[98:101], v1, s[16:19], s66 offen offset:0
    buffer_load_dwordx4 v[102:105], v1, s[16:19], s66 offen offset:2048
    buffer_load_dwordx4 v[106:109], v1, s[16:19], s67 offen offset:0
    buffer_load_dwordx4 v[110:113], v1, s[16:19], s67 offen offset:2048
    v_exp_f32 v38, v38
    v_exp_f32 v39, v39
    v_exp_f32 v40, v40
    v_exp_f32 v41, v41
    v_add_f32 v38, 1.0, v38
    v_add_f32 v39, 1.0, v39
    v_add_f32 v40, 1.0, v40
    v_add_f32 v41, 1.0, v41
    v_rcp_f32 v38, v38
    v_rcp_f32 v39, v39
    v_rcp_f32 v40, v40
    v_rcp_f32 v41, v41
    v_mul_f32 v30, v30, v38
    v_mul_f32 v31, v31, v39
    v_mul_f32 v32, v32, v40
    v_mul_f32 v33, v33, v41
    s_waitcnt lgkmcnt(8)
    v_min_u32 v6, v6, v7
    s_mov_b32 s70, 3
    v_readfirstlane_b32 s6, v6
    s_cmp_ge_u32 s6, 4
    s_cbranch_scc1 F_OL
F_OR3:
    s_cmp_lg_u32 s71, 0
    s_cbranch_scc1 F_OW
    s_waitcnt vmcnt(0)
F_OW:
    s_waitcnt vmcnt(12)
    v_max3_u32 v6, v82, v86, v90
    v_max_u32 v6, v6, v94
    v_cmp_eq_u32 vcc, -1, v6
    s_cbranch_vccnz F_EW0
F_ER0:
    s_waitcnt lgkmcnt(12)
    v_mfma_f32_32x32x16_bf16 v[50:65], v[70:73], v[82:85], 0
    s_waitcnt lgkmcnt(14)
    v_mfma_f32_32x32x16_bf16 v[34:49], v[66:69], v[82:85], 0
    ds_read_b64_tr_b16 v[66:67], v12 offset:8192
    ds_read_b64_tr_b16 v[68:69], v12 offset:9216
    ds_read_b64_tr_b16 v[70:71], v13 offset:8192
    ds_read_b64_tr_b16 v[72:73], v13 offset:9216
    s_waitcnt lgkmcnt(12)
    v_mfma_f32_32x32x16_bf16 v[50:65], v[78:81], v[86:89], v[50:65]
    s_waitcnt lgkmcnt(14)
    v_mfma_f32_32x32x16_bf16 v[34:49], v[74:77], v[86:89], v[34:49]
    ds_read_b64_tr_b16 v[74:75], v12 offset:10240
    ds_read_b64_tr_b16 v[76:77], v12 offset:11264
    ds_read_b64_tr_b16 v[78:79], v13 offset:10240
    ds_read_b64_tr_b16 v[80:81], v13 offset:11264
    ds_read_b64_tr_b16 v[82:83], v12 offset:40960
    s_branch SK29
ST29:
    s_branch F_K1
SK29:
    ds_read_b64_tr_b16 v[84:85], v12 offset:41984
    ds_read_b64_tr_b16 v[86:87], v13 offset:40960
    ds_read_b64_tr_b16 v[88:89], v13 offset:41984
    s_waitcnt lgkmcnt(15)
    v_mfma_f32_32x32x16_bf16 v[50:65], v[150:153], v[90:93], v[50:65]
    s_waitcnt lgkmcnt(15)
    v_mfma_f32_32x32x16_bf16 v[34:49], v[146:149], v[90:93], v[34:49]
    ds_read_b64_tr_b16 v[146:147], v12 offset:12288
    ds_read_b64_tr_b16 v[148:149], v12 offset:13312
    ds_read_b64_tr_b16 v[150:151], v13 offset:12288
    ds_read_b64_tr_b16 v[152:153], v13 offset:13312
    ds_read_b64 v[6:7], v162 offset:7792
    s_waitcnt lgkmcnt(15)
    v_mfma_f32_32x32x16_bf16 v[50:65], v[158:161], v[94:97], v[50:65]
    s_waitcnt lgkmcnt(15)
    v_mfma_f32_32x32x16_bf16 v[34:49], v[154:157], v[94:97], v[34:49]
    ds_read_b64_tr_b16 v[154:155], v12 offset:14336
    ds_read_b64_tr_b16 v[156:157], v12 offset:15360
    ds_read_b64_tr_b16 v[158:159], v13 offset:14336
    ds_read_b64_tr_b16 v[160:161], v13 offset:15360
    ds_read_b64_tr_b16 v[90:91], v12 offset:43008
    ds_read_b64_tr_b16 v[92:93], v12 offset:44032
    ds_read_b64_tr_b16 v[94:95], v13 offset:43008
    ds_read_b64_tr_b16 v[96:97], v13 offset:44032
    s_waitcnt lgkmcnt(8)
    v_min_u32 v6, v6, v7
    s_mov_b32 s70, 4
    v_readfirstlane_b32 s6, v6
    s_cmp_ge_u32 s6, 4
    s_cbranch_scc1 F_OL
F_OR4:
    s_waitcnt vmcnt(8)
    v_max3_u32 v6, v98, v102, v106
    v_max_u32 v6, v6, v110
    v_cmp_eq_u32 vcc, -1, v6
    s_cbranch_vccnz F_EW1
F_ER1:
    s_waitcnt lgkmcnt(15)
    v_mfma_f32_32x32x16_bf16 v[50:65], v[70:73], v[98:101], v[50:65]
    s_waitcnt lgkmcnt(15)
    v_mfma_f32_32x32x16_bf16 v[34:49], v[66:69], v[98:101], v[34:49]
    ds_read_b64_tr_b16 v[66:67], v12 offset:32768
    ds_read_b64_tr_b16 v[68:69], v12 offset:33792
    ds_read_b64_tr_b16 v[70:71], v13 offset:32768
    ds_read_b64_tr_b16 v[72:73], v13 offset:33792
    s_waitcnt lgkmcnt(15)
    v_mfma_f32_32x32x16_bf16 v[50:65], v[78:81], v[102:105], v[50:65]
    s_waitcnt lgkmcnt(15)
    v_mfma_f32_32x32x16_bf16 v[34:49], v[74:77], v[102:105], v[34:49]
    ds_read_b64_tr_b16 v[74:75], v12 offset:34816
    ds_read_b64_tr_b16 v[76:77], v12 offset:35840
    ds_read_b64_tr_b16 v[78:79], v13 offset:34816
    ds_read_b64_tr_b16 v[80:81], v13 offset:35840
    ds_read_b64_tr_b16 v[98:99], v12 offset:45056
    ds_read_b64_tr_b16 v[100:101], v12 offset:46080
    ds_read_b64_tr_b16 v[102:103], v13 offset:45056
    ds_read_b64_tr_b16 v[104:105], v13 offset:46080
    s_waitcnt lgkmcnt(15)
    v_mfma_f32_32x32x16_bf16 v[50:65], v[150:153], v[106:109], v[50:65]
    s_waitcnt lgkmcnt(15)
    v_mfma_f32_32x32x16_bf16 v[34:49], v[146:149], v[106:109], v[34:49]
    ds_read_b64_tr_b16 v[146:147], v12 offset:36864
    ds_read_b64_tr_b16 v[148:149], v12 offset:37888
    ds_read_b64_tr_b16 v[150:151], v13 offset:36864
    ds_read_b64_tr_b16 v[152:153], v13 offset:37888
    s_waitcnt lgkmcnt(15)
    v_mfma_f32_32x32x16_bf16 v[50:65], v[158:161], v[110:113], v[50:65]
    s_waitcnt lgkmcnt(15)
    v_mfma_f32_32x32x16_bf16 v[34:49], v[154:157], v[110:113], v[34:49]
    ds_read_b64_tr_b16 v[154:155], v12 offset:38912
    ds_read_b64_tr_b16 v[156:157], v12 offset:39936
    ds_read_b64_tr_b16 v[158:159], v13 offset:38912
    ds_read_b64_tr_b16 v[160:161], v13 offset:39936
    ds_read_b64_tr_b16 v[106:107], v12 offset:47104
    ds_read_b64_tr_b16 v[108:109], v12 offset:48128
    ds_read_b64_tr_b16 v[110:111], v13 offset:47104
    ds_read_b64_tr_b16 v[112:113], v13 offset:48128
    s_cmp_lg_u32 s71, 0
    s_cbranch_scc1 F_OR0
    s_mov_b32 s92, 320000
LL_48:
    ds_read_b32 v6, v162 offset:7796
    s_waitcnt lgkmcnt(0)
    v_readfirstlane_b32 s93, v6
    s_cmp_ge_u32 s93, 4
    s_cbranch_scc1 LD_49
    s_sleep 3
    s_sub_u32 s92, s92, 1
    s_cmp_lg_u32 s92, 0
    s_cbranch_scc1 LL_48
LD_49:
    s_mov_b32 s70, 0
F_OL:
    s_cmp_lg_u32 s71, 0
    s_cbranch_scc1 F_OD
F_OM:
    buffer_load_dwordx4 v[114:117], v1, s[16:19], s64 offen offset:1024 sc1
    buffer_load_dwordx4 v[118:121], v1, s[16:19], s64 offen offset:3072 sc1
    buffer_load_dwordx4 v[122:125], v1, s[16:19], s65 offen offset:1024 sc1
    buffer_load_dwordx4 v[126:129], v1, s[16:19], s65 offen offset:3072 sc1
    buffer_load_dwordx4 v[130:133], v1, s[16:19], s66 offen offset:1024 sc1
    buffer_load_dwordx4 v[134:137], v1, s[16:19], s66 offen offset:3072 sc1
    buffer_load_dwordx4 v[138:141], v1, s[16:19], s67 offen offset:1024 sc1
    buffer_load_dwordx4 v[142:145], v1, s[16:19], s67 offen offset:3072 sc1
    s_mov_b32 s71, 1
F_OD:
    s_cmp_eq_u32 s70, 3
    s_cbranch_scc1 F_OR3
    s_cmp_eq_u32 s70, 4
    s_cbranch_scc1 F_OR4
F_OR2:
F_OR0:
    s_setprio 0
    s_mov_b32 s70, 0
    s_mov_b32 s91, 40000
    s_waitcnt lgkmcnt(0)
    s_branch F_QF
F_QS:
    s_waitcnt vmcnt(0)
F_QF:
    s_bitcmp1_b32 s70, 0
    s_cbranch_scc1 F_QN0
    s_waitcnt vmcnt(6)
    v_max_u32 v6, v114, v118
    v_cmp_eq_u32 vcc, -1, v6
    s_cbranch_vccnz F_QR0
F_QM0:
    v_mfma_f32_32x32x16_bf16 v[50:65], v[70:73], v[114:117], v[50:65]
    v_mfma_f32_32x32x16_bf16 v[34:49], v[66:69], v[114:117], v[34:49]
    v_mfma_f32_32x32x16_bf16 v[50:65], v[78:81], v[118:121], v[50:65]
    v_mfma_f32_32x32x16_bf16 v[34:49], v[74:77], v[118:121], v[34:49]
    s_bitset1_b32 s70, 0
F_QN0:
    s_bitcmp1_b32 s70, 1
    s_cbranch_scc1 F_QN1
    s_waitcnt vmcnt(4)
    v_max_u32 v6, v122, v126
    v_cmp_eq_u32 vcc, -1, v6
    s_cbranch_vccnz F_QR1
F_QM1:
    v_mfma_f32_32x32x16_bf16 v[50:65], v[150:153], v[122:125], v[50:65]
    v_mfma_f32_32x32x16_bf16 v[34:49], v[146:149], v[122:125], v[34:49]
    v_mfma_f32_32x32x16_bf16 v[50:65], v[158:161], v[126:129], v[50:65]
    v_mfma_f32_32x32x16_bf16 v[34:49], v[154:157], v[126:129], v[34:49]
    s_bitset1_b32 s70, 1
F_QN1:
    s_bitcmp1_b32 s70, 2
    s_cbranch_scc1 F_QN2
    s_waitcnt vmcnt(2)
    v_max_u32 v6, v130, v134
    v_cmp_eq_u32 vcc, -1, v6
    s_cbranch_vccnz F_QR2
F_QM2:
    v_mfma_f32_32x32x16_bf16 v[50:65], v[86:89], v[130:133], v[50:65]
    v_mfma_f32_32x32x16_bf16 v[34:49], v[82:85], v[130:133], v[34:49]
    v_mfma_f32_32x32x16_bf16 v[50:65], v[94:97], v[134:137], v[50:65]
    v_mfma_f32_32x32x16_bf16 v[34:49], v[90:93], v[134:137], v[34:49]
    s_bitset1_b32 s70, 2
F_QN2:
    s_bitcmp1_b32 s70, 3
    s_cbranch_scc1 F_QN3
    s_waitcnt vmcnt(0)
    v_max_u32 v6, v138, v142
    v_cmp_eq_u32 vcc, -1, v6
    s_cbranch_vccnz F_QR3
F_QM3:
    v_mfma_f32_32x32x16_bf16 v[50:65], v[102:105], v[138:141], v[50:65]
    v_mfma_f32_32x32x16_bf16 v[34:49], v[98:101], v[138:141], v[34:49]
    v_mfma_f32_32x32x16_bf16 v[50:65], v[110:113], v[142:145], v[50:65]
    v_mfma_f32_32x32x16_bf16 v[34:49], v[106:109], v[142:145], v[34:49]
    s_bitset1_b32 s70, 3
F_QN3:
    s_cmp_eq_u32 s70, 15
    s_cbranch_scc0 F_QL
F_QD:
    v_xor_b32 v8, 32768, v10
    s_mov_b32 s92, 320000
    s_nop 5
    ds_write_b128 v10, v[50:53] offset:12288
    ds_write_b128 v10, v[54:57] offset:13312
    ds_write_b128 v10, v[58:61] offset:14336
    ds_write_b128 v10, v[62:65] offset:15360
    ds_read_b128 v[158:161], v8 offset:15360
    ds_read_b128 v[146:149], v8 offset:12288
    ds_read_b128 v[150:153], v8 offset:13312
    ds_read_b128 v[154:157], v8 offset:14336
    v_lshlrev_b32 v66, 16, v14
    v_and_b32 v67, s35, v14
    v_lshlrev_b32 v68, 16, v15
    v_and_b32 v69, s35, v15
    v_lshlrev_b32 v70, 16, v16
    v_and_b32 v71, s35, v16
    v_lshlrev_b32 v72, 16, v17
    v_and_b32 v73, s35, v17
    v_lshlrev_b32 v74, 16, v2
    v_and_b32 v75, s35, v2
    v_lshlrev_b32 v76, 16, v3
    v_and_b32 v77, s35, v3
    v_lshlrev_b32 v78, 16, v4
    v_and_b32 v79, s35, v4
    v_lshlrev_b32 v80, 16, v5
    v_and_b32 v81, s35, v5
    s_branch SK30
ST30:
    s_branch F_K1
SK30:
    v_fma_f32 v34, v34, v18, v66
    v_fma_f32 v35, v35, v19, v67
    v_fma_f32 v36, v36, v20, v68
    v_fma_f32 v37, v37, v21, v69
    v_fma_f32 v38, v38, v22, v70
    v_fma_f32 v39, v39, v23, v71
    v_fma_f32 v40, v40, v24, v72
    v_fma_f32 v41, v41, v25, v73
    v_fma_f32 v42, v42, v26, v74
    v_fma_f32 v43, v43, v27, v75
    v_fma_f32 v44, v44, v28, v76
    v_fma_f32 v45, v45, v29, v77
    v_fma_f32 v46, v46, v30, v78
    v_fma_f32 v47, v47, v31, v79
    v_fma_f32 v48, v48, v32, v80
    v_fma_f32 v49, v49, v33, v81
F_XL:
    s_waitcnt lgkmcnt(3)
    v_cmp_eq_u32 vcc, -1, v158
    s_cbranch_vccnz F_XW
F_XR:
    s_waitcnt lgkmcnt(1)
    v_fma_f32 v34, v146, v18, v34
    v_fma_f32 v35, v147, v19, v35
    v_fma_f32 v36, v148, v20, v36
    v_fma_f32 v37, v149, v21, v37
    v_fma_f32 v38, v150, v22, v38
    v_fma_f32 v39, v151, v23, v39
    v_fma_f32 v40, v152, v24, v40
    v_fma_f32 v41, v153, v25, v41
    v_cvt_pk_bf16_f32 v34, v34, v35
    v_cvt_pk_bf16_f32 v35, v36, v37
    v_cvt_pk_bf16_f32 v36, v38, v39
    v_cvt_pk_bf16_f32 v37, v40, v41
    buffer_store_dwordx4 v[34:37], v11, s[28:31], s79 offen offset:0
    s_waitcnt lgkmcnt(0)
    v_fma_f32 v42, v154, v26, v42
    v_fma_f32 v43, v155, v27, v43
    v_fma_f32 v44, v156, v28, v44
    v_fma_f32 v45, v157, v29, v45
    v_fma_f32 v46, v158, v30, v46
    v_fma_f32 v47, v159, v31, v47
    v_fma_f32 v48, v160, v32, v48
    v_fma_f32 v49, v161, v33, v49
    v_cvt_pk_bf16_f32 v42, v42, v43
    v_cvt_pk_bf16_f32 v43, v44, v45
    v_cvt_pk_bf16_f32 v44, v46, v47
    v_cvt_pk_bf16_f32 v45, v48, v49
    buffer_store_dwordx4 v[42:45], v11, s[28:31], s79 offen offset:16
    s_endpgm
F_PW1:
    s_mov_b32 s92, 40000
F_PL1:
    s_sleep 4
    buffer_load_dword v5, v2, s[16:19], s75 offen sc1
    s_sub_u32 s92, s92, 1
    s_waitcnt vmcnt(0)
    v_cmp_le_u32 s[94:95], 16, v5
    s_cmp_eq_u64 s[94:95], -1
    s_cbranch_scc1 F_PR1
    s_cmp_lg_u32 s92, 0
    s_cbranch_scc1 F_PL1
    s_branch F_PR1
F_PW2:
    s_mov_b32 s92, 40000
F_PL2:
    s_sleep 4
    buffer_load_dword v5, v2, s[16:19], s75 offen sc1
    s_sub_u32 s92, s92, 1
    s_waitcnt vmcnt(0)
    v_cmp_le_u32 s[94:95], 32, v5
    s_cmp_eq_u64 s[94:95], -1
    s_cbranch_scc1 F_PR2
    s_cmp_lg_u32 s92, 0
    s_cbranch_scc1 F_PL2
    s_branch F_PR2
F_EW0:
    s_mov_b32 s92, 40000
    s_waitcnt vmcnt(0)
F_EL0:
    v_cmp_eq_u32 vcc, -1, v82
    s_cbranch_vccz F_ET0_0
    buffer_load_dwordx4 v[82:85], v1, s[16:19], s64 offen offset:0 sc1
F_ET0_0:
    v_cmp_eq_u32 vcc, -1, v86
    s_cbranch_vccz F_ET0_1
    buffer_load_dwordx4 v[86:89], v1, s[16:19], s64 offen offset:2048 sc1
F_ET0_1:
    v_cmp_eq_u32 vcc, -1, v90
    s_cbranch_vccz F_ET0_2
    buffer_load_dwordx4 v[90:93], v1, s[16:19], s65 offen offset:0 sc1
F_ET0_2:
    v_cmp_eq_u32 vcc, -1, v94
    s_cbranch_vccz F_ET0_3
    buffer_load_dwordx4 v[94:97], v1, s[16:19], s65 offen offset:2048 sc1
F_ET0_3:
    v_cmp_eq_u32 vcc, -1, v98
    s_cbranch_vccz F_ET0_4
    buffer_load_dwordx4 v[98:101], v1, s[16:19], s66 offen offset:0 sc1
F_ET0_4:
    v_cmp_eq_u32 vcc, -1, v102
    s_cbranch_vccz F_ET0_5
    buffer_load_dwordx4 v[102:105], v1, s[16:19], s66 offen offset:2048 sc1
F_ET0_5:
    v_cmp_eq_u32 vcc, -1, v106
    s_cbranch_vccz F_ET0_6
    buffer_load_dwordx4 v[106:109], v1, s[16:19], s67 offen offset:0 sc1
F_ET0_6:
    v_cmp_eq_u32 vcc, -1, v110
    s_cbranch_vccz F_ET0_7
    buffer_load_dwordx4 v[110:113], v1, s[16:19], s67 offen offset:2048 sc1
F_ET0_7:
    s_sub_u32 s92, s92, 1
    s_waitcnt vmcnt(0)
    v_max3_u32 v6, v82, v86, v90
    v_max_u32 v6, v6, v94
    v_cmp_eq_u32 vcc, -1, v6
    s_cbranch_vccz F_ER0
    s_sleep 4
    s_cmp_lg_u32 s92, 0
    s_cbranch_scc1 F_EL0
    s_branch F_ER0
F_EW1:
    s_mov_b32 s92, 40000
    s_waitcnt vmcnt(0)
F_EL1:
    v_cmp_eq_u32 vcc, -1, v98
    s_cbranch_vccz F_ET1_4
    buffer_load_dwordx4 v[98:101], v1, s[16:19], s66 offen offset:0 sc1
F_ET1_4:
    v_cmp_eq_u32 vcc, -1, v102
    s_cbranch_vccz F_ET1_5
    buffer_load_dwordx4 v[102:105], v1, s[16:19], s66 offen offset:2048 sc1
F_ET1_5:
    v_cmp_eq_u32 vcc, -1, v106
    s_cbranch_vccz F_ET1_6
    buffer_load_dwordx4 v[106:109], v1, s[16:19], s67 offen offset:0 sc1
F_ET1_6:
    v_cmp_eq_u32 vcc, -1, v110
    s_cbranch_vccz F_ET1_7
    buffer_load_dwordx4 v[110:113], v1, s[16:19], s67 offen offset:2048 sc1
F_ET1_7:
    s_sub_u32 s92, s92, 1
    s_waitcnt vmcnt(0)
    v_max3_u32 v6, v98, v102, v106
    v_max_u32 v6, v6, v110
    v_cmp_eq_u32 vcc, -1, v6
    s_cbranch_vccz F_ER1
    s_sleep 4
    s_cmp_lg_u32 s92, 0
    s_cbranch_scc1 F_EL1
    s_branch F_ER1
F_QR0:
    s_cmp_eq_u32 s91, 0
    s_cbranch_scc1 F_QM0
    v_cmp_eq_u32 vcc, -1, v114
    s_cbranch_vccz F_QT8
    buffer_load_dwordx4 v[114:117], v1, s[16:19], s64 offen offset:1024 sc1
F_QT8:
    v_cmp_eq_u32 vcc, -1, v118
    s_cbranch_vccz F_QT9
    buffer_load_dwordx4 v[118:121], v1, s[16:19], s64 offen offset:3072 sc1
F_QT9:
    s_branch F_QN0
F_QR1:
    s_cmp_eq_u32 s91, 0
    s_cbranch_scc1 F_QM1
    v_cmp_eq_u32 vcc, -1, v122
    s_cbranch_vccz F_QT10
    buffer_load_dwordx4 v[122:125], v1, s[16:19], s65 offen offset:1024 sc1
F_QT10:
    v_cmp_eq_u32 vcc, -1, v126
    s_cbranch_vccz F_QT11
    buffer_load_dwordx4 v[126:129], v1, s[16:19], s65 offen offset:3072 sc1
F_QT11:
    s_branch F_QN1
F_QR2:
    s_cmp_eq_u32 s91, 0
    s_cbranch_scc1 F_QM2
    v_cmp_eq_u32 vcc, -1, v130
    s_cbranch_vccz F_QT12
    buffer_load_dwordx4 v[130:133], v1, s[16:19], s66 offen offset:1024 sc1
F_QT12:
    v_cmp_eq_u32 vcc, -1, v134
    s_cbranch_vccz F_QT13
    buffer_load_dwordx4 v[134:137], v1, s[16:19], s66 offen offset:3072 sc1
F_QT13:
    s_branch F_QN2
F_QR3:
    s_cmp_eq_u32 s91, 0
    s_cbranch_scc1 F_QM3
    v_cmp_eq_u32 vcc, -1, v138
    s_cbranch_vccz F_QT14
    buffer_load_dwordx4 v[138:141], v1, s[16:19], s67 offen offset:1024 sc1
F_QT14:
    v_cmp_eq_u32 vcc, -1, v142
    s_cbranch_vccz F_QT15
    buffer_load_dwordx4 v[142:145], v1, s[16:19], s67 offen offset:3072 sc1
F_QT15:
    s_branch F_QN3
F_QL:
    s_sub_u32 s91, s91, 1
    s_sleep 1
    s_branch F_QS
F_XW:
    s_sub_u32 s92, s92, 1
    s_cbranch_scc1 F_XR
    s_waitcnt lgkmcnt(0)
    ds_read_b128 v[158:161], v8 offset:15360
    ds_read_b128 v[146:149], v8 offset:12288
    ds_read_b128 v[150:153], v8 offset:13312
    ds_read_b128 v[154:157], v8 offset:14336
    s_branch F_XL
FA_FB:
    s_mov_b32 s67, s63
    s_mov_b32 s69, 0
    v_mov_b32 v4, 0xff800000
    s_waitcnt vmcnt(0)
FA_FB1:
    buffer_load_dwordx4 v[8:11], v1, s[16:19], s67 offen sc1
    s_add_u32 s67, s67, 2048
    s_add_u32 s69, s69, 1
    s_waitcnt vmcnt(0)
    v_mfma_f32_32x32x16_bf16 v[40:55], v[8:11], v[72:75], 0
    s_nop 11
    v_max3_f32 v4, v40, v41, v4
    v_max3_f32 v4, v42, v43, v4
    v_max3_f32 v4, v44, v45, v4
    v_max3_f32 v4, v46, v47, v4
    v_max3_f32 v4, v48, v49, v4
    v_max3_f32 v4, v50, v51, v4
    v_max3_f32 v4, v52, v53, v4
    v_max3_f32 v4, v54, v55, v4
    s_cmp_lt_u32 s69, 64
    s_cbranch_scc1 FA_FB1
    v_mov_b32 v5, v4
    s_nop 1
    v_permlane32_swap_b32 v4, v5
    v_max_f32 v4, v4, v5
    v_sub_f32 v56, 0, v4
    v_mov_b32 v88, 0
    v_sub_f32 v57, 0, v4
    v_mov_b32 v89, 0
    v_sub_f32 v58, 0, v4
    v_mov_b32 v90, 0
    v_sub_f32 v59, 0, v4
    v_mov_b32 v91, 0
    v_sub_f32 v60, 0, v4
    v_mov_b32 v92, 0
    v_sub_f32 v61, 0, v4
    v_mov_b32 v93, 0
    v_sub_f32 v62, 0, v4
    v_mov_b32 v94, 0
    v_sub_f32 v63, 0, v4
    v_mov_b32 v95, 0
    v_sub_f32 v64, 0, v4
    v_mov_b32 v96, 0
    v_sub_f32 v65, 0, v4
    v_mov_b32 v97, 0
    v_sub_f32 v66, 0, v4
    v_mov_b32 v98, 0
    v_sub_f32 v67, 0, v4
    v_mov_b32 v99, 0
    v_sub_f32 v68, 0, v4
    v_mov_b32 v100, 0
    v_sub_f32 v69, 0, v4
    v_mov_b32 v101, 0
    v_sub_f32 v70, 0, v4
    v_mov_b32 v102, 0
    v_sub_f32 v71, 0, v4
    v_mov_b32 v103, 0
    s_mov_b32 s67, s63
    s_mov_b32 s69, 0
FA_FB2:
    buffer_load_dwordx4 v[8:11], v1, s[16:19], s67 offen sc1
    s_mov_b64 exec, s[70:71]
    buffer_load_dwordx4 v[12:15], v2, s[16:19], s67 offen offset:1024 sc1
    buffer_load_dwordx4 v[16:19], v2, s[16:19], s67 offen offset:1536 sc1
    s_mov_b64 exec, -1
    s_add_u32 s67, s67, 2048
    s_add_u32 s69, s69, 1
    s_waitcnt vmcnt(0)
    v_mfma_f32_32x32x16_bf16 v[40:55], v[8:11], v[72:75], v[56:71]
    s_nop 11
    v_exp_f32 v40, v40
    v_exp_f32 v41, v41
    v_exp_f32 v42, v42
    v_exp_f32 v43, v43
    v_exp_f32 v44, v44
    v_exp_f32 v45, v45
    v_exp_f32 v46, v46
    v_exp_f32 v47, v47
    v_exp_f32 v48, v48
    v_exp_f32 v49, v49
    v_exp_f32 v50, v50
    v_exp_f32 v51, v51
    v_exp_f32 v52, v52
    v_exp_f32 v53, v53
    v_exp_f32 v54, v54
    v_exp_f32 v55, v55
    v_smfmac_f32_32x32x32_bf16 v[88:103], v[12:15], v[40:47], v39
    s_nop 0
    v_smfmac_f32_32x32x32_bf16 v[88:103], v[16:19], v[48:55], v39
    s_cmp_lt_u32 s69, 64
    s_cbranch_scc1 FA_FB2
    s_nop 12
    s_nop 8
    s_branch FA_NORM
F_END:
    s_endpgm
.section .rodata,"a"
.p2align 6
.amdhsa_kernel f_kernel
  .amdhsa_next_free_vgpr 168
  .amdhsa_next_free_sgpr 102
  .amdhsa_accum_offset 168
  .amdhsa_group_segment_fixed_size 0
  .amdhsa_kernarg_size 88
  .amdhsa_user_sgpr_count 2
  .amdhsa_user_sgpr_kernarg_segment_ptr 1
  .amdhsa_system_sgpr_workgroup_id_x 1
.end_amdhsa_kernel
```
